```python
import torch

def _softmax(x, axis=-1):
    return torch.softmax(x, dim=axis)
def _gelu(x):
    return torch.nn.functional.gelu(x, approximate="tanh")
def _silu(x):
    return torch.nn.functional.silu(x)
def _sigmoid(x):
    return torch.sigmoid(x)
def _layernorm(x, axis=-1, eps=1e-5):
    m = x.mean(dim=axis, keepdim=True)
    v = x.var(dim=axis, keepdim=True, unbiased=False)
    return (x - m) / torch.sqrt(v + eps)
def _scatter_add(tgt, idx, src, axis=0):
    return tgt.clone().index_add_(axis, idx, src)
def _segment_sum(src, seg, n):
    out = torch.zeros((n,) + src.shape[1:], dtype=src.dtype)
    return out.index_add_(0, seg, src)
def _pad(x, pw):
    flat = tuple(v for pair in reversed(pw) for v in pair)
    return torch.nn.functional.pad(x, flat)

kernel_name = 'parallel_sum__ssm_conv_h3__mixer_channel_mlp__prompt'

def setup_inputs():

    _w = (lambda a: (lambda t: t.to(torch.bfloat16) if t.is_floating_point() else t)(torch.as_tensor(a)))
    def _A_setup():
        B, S, D = 1, 2048, 512
        ks = 4
        return {
            "q": _w((lambda *s: torch.randn(*s, dtype=torch.bfloat16) * 0.05)(B, S, D)),
            "k": _w((lambda *s: torch.randn(*s, dtype=torch.bfloat16) * 0.2)(B, S, D)),
            "v": _w((lambda *s: torch.randn(*s, dtype=torch.bfloat16) * 0.2)(B, S, D)),
            "shift_k": _w((lambda *s: torch.randn(*s, dtype=torch.bfloat16) * 0.2)(D, ks) * 0.5),
            "ssm_k": _w((lambda *s: torch.randn(*s, dtype=torch.bfloat16) * 0.8)(D, S) * (1.0 / S ** 0.5)),
            "ssm_D": _w((lambda *s: torch.randn(*s, dtype=torch.bfloat16) * 0.2)(D)),
        }
    _A_in = _A_setup()

    def _B_setup():
        B, S, D, F = 1, 2048, 512, 1376
        return {
            "x": _w((lambda *s: torch.randn(*s, dtype=torch.bfloat16) * 0.05)(B, S, D)),
            "w1": _w((lambda *s: torch.randn(*s, dtype=torch.bfloat16) * 0.8)(D, F) * (D ** -0.5)),
            "b1": _w((lambda *s: torch.randn(*s, dtype=torch.bfloat16) * 0.4)(F)),
            "w2": _w((lambda *s: torch.randn(*s, dtype=torch.bfloat16) * 0.05)(F, D) * (F ** -0.5)),
            "b2": _w((lambda *s: torch.randn(*s, dtype=torch.bfloat16) * 0.05)(D)),
        }
    _B_in = _B_setup()

    return {
        "A_q": _A_in["q"],
        "A_k": _A_in["k"],
        "A_v": _A_in["v"],
        "A_shift_k": _A_in["shift_k"],
        "A_ssm_k": _A_in["ssm_k"],
        "A_ssm_D": _A_in["ssm_D"],
        "B_x": _B_in["x"],
        "B_w1": _B_in["w1"],
        "B_b1": _B_in["b1"],
        "B_w2": _B_in["w2"],
        "B_b2": _B_in["b2"],
    }

def reference(A_q, A_k, A_v, A_shift_k, A_ssm_k, A_ssm_D, B_x, B_w1, B_b1, B_w2, B_b2):
    def _A_ref(q, k, v, shift_k, ssm_k, ssm_D):
        B, S, D = q.shape
        ks = shift_k.shape[-1]
        k_pad = _pad(k, ((0, 0), (ks - 1, 0), (0, 0)))
        k_shift = torch.zeros_like(k)
        for t in range(ks):
            k_shift = k_shift + k_pad[:, t:t + S, :] * shift_k[:, ks - 1 - t][None, None, :]
        kv = k_shift * v
        L = 2 * S
        kv_pad = _pad(kv, ((0, 0), (0, S), (0, 0)))
        kf_pad = _pad(ssm_k, ((0, 0), (0, S)))
        kv_f = (lambda x, axes=(-2,-1): torch.fft.rfft2(x.float(), dim=axes))(kv_pad[:, None, :, :], axes=(1, 2))
        kf_f = (lambda x, axes=(-2,-1): torch.fft.rfft2(x.float(), dim=axes))(kf_pad[:, None, :], axes=(1, 2))
        kf_f = (lambda x, *d: x.permute(*d))(kf_f, 1, 2, 0)
        y_f = kv_f * kf_f[None, :, :, :]
        y = (lambda x, s, axes=(-2,-1): torch.fft.irfft2(x, s=s, dim=axes).to(torch.bfloat16))(y_f, (1, L), axes=(1, 2))[:, 0, :S, :]
        y = y + kv * ssm_D[None, None, :]
        return q * y

    def _B_ref(x, w1, b1, w2, b2):
        y = _layernorm(x, axis=-1)
        h = _gelu(torch.einsum("bsd,df->bsf", y, w1) + b1)
        return torch.einsum("bsf,fd->bsd", h, w2) + b2

    x = A_q
    xn = _layernorm(x, axis=-1)
    return x + _A_ref(xn, A_k, A_v, A_shift_k, A_ssm_k, A_ssm_D) + _B_ref(xn, B_w1, B_b1, B_w2, B_b2)
```

```asm
; @launch grid=(256,1,1) block=(512,1,1) lds=163840
.amdgcn_target "amdgcn-amd-amdhsa--gfx950"
.text
.p2align 12
    .fill 788, 4, 0xbf810000
M_MAIN:
    s_load_dwordx2 s[16:17], s[0:1], 72
    s_mov_b32 s18, 1409024
    s_mov_b32 s19, 0x20000
    s_mul_i32 s67, s3, 360448
    s_lshl_b32 s60, s7, 7
    s_add_u32 s67, s67, s60
    s_mul_i32 s60, s7, 0
    s_mul_i32 s61, s78, 0
    s_add_u32 s60, s60, s61
    s_cmp_eq_u32 s3, 3
    s_cselect_b32 s61, 8, 9
    s_add_u32 s24, s60, 0
    s_and_b32 s24, s24, 3
    s_mul_i32 s24, s24, 3
    s_min_u32 s24, s24, s61
    s_mul_i32 s24, s24, 32768
    s_add_u32 s24, s24, s67
    s_add_u32 s25, s60, 1
    s_and_b32 s25, s25, 3
    s_mul_i32 s25, s25, 3
    s_min_u32 s25, s25, s61
    s_mul_i32 s25, s25, 32768
    s_add_u32 s25, s25, s67
    s_add_u32 s26, s60, 2
    s_and_b32 s26, s26, 3
    s_mul_i32 s26, s26, 3
    s_min_u32 s26, s26, s61
    s_mul_i32 s26, s26, 32768
    s_add_u32 s26, s26, s67
    s_add_u32 s27, s60, 3
    s_and_b32 s27, s27, 3
    s_mul_i32 s27, s27, 3
    s_min_u32 s27, s27, s61
    s_mul_i32 s27, s27, 32768
    s_add_u32 s27, s27, s67
    v_and_b32 v7, 31, v1
    v_and_b32 v11, 12, v1
    v_lshlrev_b32 v11, 4, v11
    v_and_b32 v8, 16, v1
    v_lshl_or_b32 v11, v8, 1, v11
    v_and_b32 v8, 3, v1
    v_lshl_or_b32 v11, v8, 3, v11
    s_lshl_b32 s70, s3, 12
    v_lshrrev_b32 v8, 5, v1
    v_lshl_add_u32 v31, v8, 8, v11
    v_add_u32 v31, s64, v31
    v_lshrrev_b32 v8, 4, v1
    v_bfe_u32 v9, v1, 1, 3
    v_xor_b32 v9, v9, v8
    v_lshlrev_b32 v9, 4, v9
    v_and_b32 v10, 15, v1
    v_lshl_or_b32 v9, v10, 7, v9
    v_add_u32 v9, s70, v9
    v_lshlrev_b32 v30, 4, v10
    v_lshl_or_b32 v30, v8, 9, v30
    v_mul_u32_u24 v10, 1536, v8
    v_add_u32 v10, v10, v11
    s_add_u32 s60, s3, 0
    s_and_b32 s60, s60, 1
    s_lshl_b32 s61, s60, 6
    s_mul_i32 s60, s60, 6144
    s_add_u32 s60, s60, 16384
    v_xor_b32 v66, s61, v9
    v_add_u32 v70, s60, v10
    v_xor_b32 v71, 32, v70
    v_add_u32 v68, 57344, v66
    v_add_u32 v74, 57344, v70
    v_add_u32 v75, 57344, v71
    s_add_u32 s60, s3, 1
    s_and_b32 s60, s60, 1
    s_lshl_b32 s61, s60, 6
    s_mul_i32 s60, s60, 6144
    s_add_u32 s60, s60, 16384
    v_xor_b32 v67, s61, v9
    v_add_u32 v72, s60, v10
    v_xor_b32 v73, 32, v72
    v_add_u32 v69, 57344, v67
    v_add_u32 v76, 57344, v72
    v_add_u32 v77, 57344, v73
    s_lshl_b32 s81, s3, 11
    s_mov_b32 vcc_lo, 0x00010001
    s_mov_b32 vcc_hi, 0x00010001
    v_mov_b32 v8, 0x3f803f80
    v_cndmask_b32 v80, 0, v8, vcc
    v_mov_b32 v81, v80
    v_mov_b32 v82, v80
    v_mov_b32 v83, v80
    s_lshl_b32 s60, s4, 18
    s_sub_u32 s61, 127, s77
    s_lshl_b32 s61, s61, 6
    s_add_u32 s60, s60, s61
    s_add_u32 s74, s60, 2097152
    s_add_u32 s75, s74, 8192
    v_lshrrev_b32 v8, 2, v1
    v_and_b32 v9, 48, v3
    v_lshl_or_b32 v78, v8, 14, v9
    v_lshrrev_b32 v8, 5, v1
    v_lshl_add_u32 v24, v8, 9, v11
    v_add_u32 v24, s81, v24
    v_add_u32 v25, 65536, v24
    v_add_u32 v26, 88064, v3
    v_and_b32 v9, 7, v1
    v_bfe_u32 v10, v1, 1, 1
    v_lshl_or_b32 v10, v10, 3, v9
    v_xor_b32 v10, v10, v8
    v_lshlrev_b32 v10, 4, v10
    v_lshl_or_b32 v10, v9, 8, v10
    v_bfe_u32 v9, v1, 3, 2
    v_lshl_or_b32 v10, v9, 13, v10
    v_add_u32 v16, s81, v10
    v_xor_b32 v17, 32, v16
    v_xor_b32 v18, 64, v16
    v_xor_b32 v19, 96, v16
    v_xor_b32 v20, 128, v16
    v_xor_b32 v21, 160, v16
    v_xor_b32 v22, 192, v16
    v_xor_b32 v23, 224, v16
    s_lshl_b32 s63, s52, 1
    s_add_u32 s63, s63, s6
    s_lshl_b32 s62, s63, 3
    s_add_u32 s62, s62, s3
    s_lshl_b32 s62, s62, 10
    s_add_u32 s73, s62, 262144
    s_mul_i32 s72, s63, 172
    s_mul_i32 s64, s3, 22
    s_add_u32 s72, s72, s64
    s_lshl_b32 s72, s72, 10
    s_add_u32 s72, s72, 8388608
    s_mul_i32 s60, s7, 0
    s_mul_i32 s61, s78, 0
    s_add_u32 s60, s60, s61
    s_cmp_eq_u32 s3, 3
    s_cselect_b32 s61, 8, 9
    s_add_u32 s40, s60, 0
    s_and_b32 s40, s40, 3
    s_mul_i32 s40, s40, 3
    s_min_u32 s40, s40, s61
    s_mul_i32 s40, s40, 2048
    s_add_u32 s40, s40, s72
    s_add_u32 s41, s60, 1
    s_and_b32 s41, s41, 3
    s_mul_i32 s41, s41, 3
    s_min_u32 s41, s41, s61
    s_mul_i32 s41, s41, 2048
    s_add_u32 s41, s41, s72
    s_add_u32 s42, s60, 2
    s_and_b32 s42, s42, 3
    s_mul_i32 s42, s42, 3
    s_min_u32 s42, s42, s61
    s_mul_i32 s42, s42, 2048
    s_add_u32 s42, s42, s72
    s_add_u32 s43, s60, 3
    s_and_b32 s43, s43, 3
    s_mul_i32 s43, s43, 3
    s_min_u32 s43, s43, s61
    s_mul_i32 s43, s43, 2048
    s_add_u32 s43, s43, s72
    v_lshrrev_b32 v9, 1, v1
    v_and_b32 v10, 1, v1
    v_lshlrev_b32 v9, 8, v9
    v_lshl_or_b32 v29, v10, 12, v9
    s_waitcnt vmcnt(7)
    v_lshlrev_b32 v88, 16, v32
    v_and_b32 v89, 0xffff0000, v32
    v_lshlrev_b32 v90, 16, v33
    v_and_b32 v91, 0xffff0000, v33
    v_lshlrev_b32 v92, 16, v34
    v_and_b32 v93, 0xffff0000, v34
    v_lshlrev_b32 v94, 16, v35
    v_and_b32 v95, 0xffff0000, v35
    s_waitcnt vmcnt(6)
    v_lshlrev_b32 v96, 16, v36
    v_and_b32 v97, 0xffff0000, v36
    v_lshlrev_b32 v98, 16, v37
    v_and_b32 v99, 0xffff0000, v37
    v_lshlrev_b32 v100, 16, v38
    v_and_b32 v101, 0xffff0000, v38
    v_lshlrev_b32 v102, 16, v39
    v_and_b32 v103, 0xffff0000, v39
    v_add_f32 v8, v88, v89
    v_add_f32 v8, v8, v90
    v_add_f32 v8, v8, v91
    v_add_f32 v8, v8, v92
    v_add_f32 v8, v8, v93
    v_add_f32 v8, v8, v94
    v_add_f32 v8, v8, v95
    v_add_f32 v9, v96, v97
    v_add_f32 v9, v9, v98
    v_add_f32 v9, v9, v99
    v_add_f32 v9, v9, v100
    v_add_f32 v9, v9, v101
    v_add_f32 v9, v9, v102
    v_add_f32 v9, v9, v103
    v_add_f32_dpp v8, v8, v8 quad_perm:[1,0,3,2] row_mask:0xf bank_mask:0xf
    s_nop 0
    v_add_f32_dpp v9, v9, v9 quad_perm:[1,0,3,2] row_mask:0xf bank_mask:0xf
    v_add_f32_dpp v8, v8, v8 quad_perm:[2,3,0,1] row_mask:0xf bank_mask:0xf
    s_nop 0
    v_add_f32_dpp v9, v9, v9 quad_perm:[2,3,0,1] row_mask:0xf bank_mask:0xf
    v_add_f32_dpp v8, v8, v8 row_half_mirror row_mask:0xf bank_mask:0xf
    s_nop 0
    v_add_f32_dpp v9, v9, v9 row_half_mirror row_mask:0xf bank_mask:0xf
    v_add_f32_dpp v8, v8, v8 row_mirror row_mask:0xf bank_mask:0xf
    s_nop 0
    v_add_f32_dpp v9, v9, v9 row_mirror row_mask:0xf bank_mask:0xf
    v_add_f32_dpp v8, v8, v8 row_bcast:15 row_mask:0xa bank_mask:0xf
    s_nop 0
    v_add_f32_dpp v9, v9, v9 row_bcast:15 row_mask:0xa bank_mask:0xf
    v_add_f32_dpp v8, v8, v8 row_bcast:31 row_mask:0xc bank_mask:0xf
    s_nop 0
    v_add_f32_dpp v9, v9, v9 row_bcast:31 row_mask:0xc bank_mask:0xf
    v_mul_f32 v8, 0x3b000000, v8
    v_mul_f32 v9, 0x3b000000, v9
    v_readlane_b32 s60, v8, 63
    v_readlane_b32 s61, v9, 63
    s_nop 0
    v_subrev_f32 v88, s60, v88
    v_subrev_f32 v89, s60, v89
    v_subrev_f32 v90, s60, v90
    v_subrev_f32 v91, s60, v91
    v_subrev_f32 v92, s60, v92
    v_subrev_f32 v93, s60, v93
    v_subrev_f32 v94, s60, v94
    v_subrev_f32 v95, s60, v95
    v_mul_f32 v8, v88, v88
    v_fmac_f32 v8, v89, v89
    v_fmac_f32 v8, v90, v90
    v_fmac_f32 v8, v91, v91
    v_fmac_f32 v8, v92, v92
    v_fmac_f32 v8, v93, v93
    v_fmac_f32 v8, v94, v94
    v_fmac_f32 v8, v95, v95
    v_subrev_f32 v96, s61, v96
    v_subrev_f32 v97, s61, v97
    v_subrev_f32 v98, s61, v98
    v_subrev_f32 v99, s61, v99
    v_subrev_f32 v100, s61, v100
    v_subrev_f32 v101, s61, v101
    v_subrev_f32 v102, s61, v102
    v_subrev_f32 v103, s61, v103
    v_mul_f32 v9, v96, v96
    v_fmac_f32 v9, v97, v97
    v_fmac_f32 v9, v98, v98
    v_fmac_f32 v9, v99, v99
    v_fmac_f32 v9, v100, v100
    v_fmac_f32 v9, v101, v101
    v_fmac_f32 v9, v102, v102
    v_fmac_f32 v9, v103, v103
    v_add_f32_dpp v8, v8, v8 quad_perm:[1,0,3,2] row_mask:0xf bank_mask:0xf
    s_nop 0
    v_add_f32_dpp v9, v9, v9 quad_perm:[1,0,3,2] row_mask:0xf bank_mask:0xf
    v_add_f32_dpp v8, v8, v8 quad_perm:[2,3,0,1] row_mask:0xf bank_mask:0xf
    s_nop 0
    v_add_f32_dpp v9, v9, v9 quad_perm:[2,3,0,1] row_mask:0xf bank_mask:0xf
    v_add_f32_dpp v8, v8, v8 row_half_mirror row_mask:0xf bank_mask:0xf
    s_nop 0
    v_add_f32_dpp v9, v9, v9 row_half_mirror row_mask:0xf bank_mask:0xf
    v_add_f32_dpp v8, v8, v8 row_mirror row_mask:0xf bank_mask:0xf
    s_nop 0
    v_add_f32_dpp v9, v9, v9 row_mirror row_mask:0xf bank_mask:0xf
    v_add_f32_dpp v8, v8, v8 row_bcast:15 row_mask:0xa bank_mask:0xf
    s_nop 0
    v_add_f32_dpp v9, v9, v9 row_bcast:15 row_mask:0xa bank_mask:0xf
    v_add_f32_dpp v8, v8, v8 row_bcast:31 row_mask:0xc bank_mask:0xf
    s_nop 0
    v_add_f32_dpp v9, v9, v9 row_bcast:31 row_mask:0xc bank_mask:0xf
    v_mul_f32 v8, 0x3b000000, v8
    v_mul_f32 v9, 0x3b000000, v9
    s_waitcnt lgkmcnt(0)
    s_add_u32 s79, s79, 2654435761
    v_mov_b32 v4, s79
    v_readlane_b32 s63, v8, 63
    v_readlane_b32 s64, v9, 63
    v_mov_b32 v32, s60
    v_mov_b32 v33, v4
    v_mov_b32 v35, v4
    v_mov_b32 v34, s63
    v_writelane_b32 v32, s61, 1
    v_writelane_b32 v34, s64, 1
    s_lshl_b32 s83, s76, 5
    s_add_u32 s83, s83, 65536
    s_lshl_b32 s62, s52, 2
    s_add_u32 s62, s62, s3
    s_mul_i32 s66, s62, 86
    s_lshl_b32 s63, s54, 1
    s_add_u32 s66, s66, s63
    s_lshl_b32 s66, s66, 10
    s_add_u32 s66, s66, 8388608
    s_lshl_b32 s62, s62, 4
    s_add_u32 s62, s62, s53
    s_lshl_b32 s62, s62, 8
    s_add_u32 s76, s62, 262144
    v_not_b32 v36, v4
    v_not_b32 v37, v4
    v_not_b32 v38, v4
    v_not_b32 v39, v4
    s_mov_b32 s84, s16
    s_mov_b32 s85, s17
    s_mov_b32 s87, 0x20000
    s_mov_b32 s88, s20
    s_mov_b32 s89, s21
    s_mov_b32 s91, 0x20000
    s_cmp_eq_u32 s3, 3
    s_cselect_b32 s86, 0, s18
    s_cselect_b32 s90, 0, s22
    v_add_u32 v6, 8192, v6
    v_lshlrev_b32 v79, 4, v7
    v_lshrrev_b32 v86, 3, v1
    v_lshlrev_b32 v86, 7, v86
    s_lshr_b32 s60, s3, 1
    s_mul_i32 s60, s60, 768
    s_and_b32 s61, s3, 1
    s_lshl_b32 s61, s61, 6
    s_add_u32 s60, s60, s61
    s_add_u32 s60, s60, 156928
    v_min_u32 v8, 16, v1
    v_and_b32 v8, 16, v8
    v_and_b32 v9, 15, v1
    v_lshl_or_b32 v8, v8, 1, v9
    v_lshl_add_u32 v84, v8, 2, s60
    s_lshl_b32 s62, s52, 11
    s_lshl_b32 s63, s3, 9
    s_add_u32 s62, s62, s63
    s_add_u32 s62, s62, 65536
    s_lshl_b32 s63, s4, 12
    s_add_u32 s63, s63, 32768
    s_lshl_b32 s64, s5, 7
    s_add_u32 s64, s64, s63
    s_lshl_b32 s60, s3, 10
    s_add_u32 s63, s63, s60
    v_mov_b32 v12, v4
    v_mov_b32 v13, v4
    v_mov_b32 v14, v4
    v_mov_b32 v15, v4
    v_lshlrev_b32 v87, 2, v1
    v_add_u32 v87, 156928, v87
    s_waitcnt vmcnt(1)
    ds_read_b64_tr_b16 v[88:89], v31 offset:512
    ds_read_b64_tr_b16 v[90:91], v31 offset:1024
    ds_read_b64_tr_b16 v[92:93], v31 offset:1536
    ds_read_b64_tr_b16 v[94:95], v31 offset:2048
    ds_read_b64_tr_b16 v[96:97], v31 offset:2560
    ds_read_b64_tr_b16 v[108:109], v31 offset:3072
    ds_read_b64_tr_b16 v[110:111], v31 offset:3584
    ds_read_b64_tr_b16 v[112:113], v31 offset:4096
    ds_read_b64_tr_b16 v[114:115], v31 offset:4608
    s_waitcnt vmcnt(0)
    v_alignbit_b32 v64, v64, v64, 16
    v_alignbit_b32 v65, v65, v65, 16
    s_waitcnt lgkmcnt(8)
    v_alignbit_b32 v99, v89, v88, 16
    s_waitcnt lgkmcnt(7)
    v_alignbit_b32 v100, v90, v89, 16
    v_alignbit_b32 v101, v91, v90, 16
    s_waitcnt lgkmcnt(6)
    v_alignbit_b32 v102, v92, v91, 16
    v_alignbit_b32 v103, v93, v92, 16
    s_waitcnt lgkmcnt(5)
    v_alignbit_b32 v104, v94, v93, 16
    v_alignbit_b32 v105, v95, v94, 16
    s_waitcnt lgkmcnt(4)
    v_alignbit_b32 v106, v96, v95, 16
    v_alignbit_b32 v107, v97, v96, 16
    v_dot2_f32_bf16 v116, v99, v65, 0
    v_dot2_f32_bf16 v117, v89, v65, 0
    v_dot2_f32_bf16 v118, v100, v65, 0
    v_dot2_f32_bf16 v119, v90, v65, 0
    v_dot2_f32_bf16 v120, v101, v65, 0
    v_dot2_f32_bf16 v121, v91, v65, 0
    v_dot2_f32_bf16 v122, v102, v65, 0
    v_dot2_f32_bf16 v123, v92, v65, 0
    v_dot2_f32_bf16 v124, v103, v65, 0
    v_dot2_f32_bf16 v125, v93, v65, 0
    v_dot2_f32_bf16 v126, v104, v65, 0
    v_dot2_f32_bf16 v127, v94, v65, 0
    v_dot2_f32_bf16 v128, v105, v65, 0
    v_dot2_f32_bf16 v129, v95, v65, 0
    v_dot2_f32_bf16 v130, v106, v65, 0
    v_dot2_f32_bf16 v131, v96, v65, 0
    v_dot2_f32_bf16 v116, v100, v64, v116
    v_dot2_f32_bf16 v117, v90, v64, v117
    v_dot2_f32_bf16 v118, v101, v64, v118
    v_dot2_f32_bf16 v119, v91, v64, v119
    v_dot2_f32_bf16 v120, v102, v64, v120
    v_dot2_f32_bf16 v121, v92, v64, v121
    v_dot2_f32_bf16 v122, v103, v64, v122
    v_dot2_f32_bf16 v123, v93, v64, v123
    v_dot2_f32_bf16 v124, v104, v64, v124
    v_dot2_f32_bf16 v125, v94, v64, v125
    v_dot2_f32_bf16 v126, v105, v64, v126
    v_dot2_f32_bf16 v127, v95, v64, v127
    v_dot2_f32_bf16 v128, v106, v64, v128
    v_dot2_f32_bf16 v129, v96, v64, v129
    v_dot2_f32_bf16 v130, v107, v64, v130
    v_dot2_f32_bf16 v131, v97, v64, v131
    s_waitcnt lgkmcnt(3)
    v_lshlrev_b32 v132, 16, v108
    v_and_b32 v133, 0xffff0000, v108
    v_lshlrev_b32 v134, 16, v109
    v_and_b32 v135, 0xffff0000, v109
    s_waitcnt lgkmcnt(2)
    v_lshlrev_b32 v136, 16, v110
    v_and_b32 v137, 0xffff0000, v110
    v_lshlrev_b32 v138, 16, v111
    v_and_b32 v139, 0xffff0000, v111
    s_waitcnt lgkmcnt(1)
    v_lshlrev_b32 v140, 16, v112
    v_and_b32 v141, 0xffff0000, v112
    v_lshlrev_b32 v142, 16, v113
    v_and_b32 v143, 0xffff0000, v113
    s_waitcnt lgkmcnt(0)
    v_lshlrev_b32 v144, 16, v114
    v_and_b32 v145, 0xffff0000, v114
    v_lshlrev_b32 v146, 16, v115
    v_and_b32 v147, 0xffff0000, v115
    v_pk_mul_f32 v[116:117], v[116:117], v[132:133]
    v_pk_mul_f32 v[118:119], v[118:119], v[134:135]
    v_pk_mul_f32 v[120:121], v[120:121], v[136:137]
    v_pk_mul_f32 v[122:123], v[122:123], v[138:139]
    v_pk_mul_f32 v[124:125], v[124:125], v[140:141]
    v_pk_mul_f32 v[126:127], v[126:127], v[142:143]
    v_pk_mul_f32 v[128:129], v[128:129], v[144:145]
    v_pk_mul_f32 v[130:131], v[130:131], v[146:147]
    v_cvt_pk_bf16_f32 v148, v131, v130
    v_cvt_pk_bf16_f32 v149, v129, v128
    v_cvt_pk_bf16_f32 v150, v127, v126
    v_cvt_pk_bf16_f32 v151, v125, v124
    v_cvt_pk_bf16_f32 v152, v123, v122
    v_cvt_pk_bf16_f32 v153, v121, v120
    v_cvt_pk_bf16_f32 v154, v119, v118
    v_cvt_pk_bf16_f32 v155, v117, v116
    s_mov_b32 vcc_lo, 0x33333333
    s_mov_b32 vcc_hi, 0x33333333
    v_cndmask_b32_dpp v156, v152, v148, vcc quad_perm:[2,3,0,1] row_mask:0xf bank_mask:0xf
    v_cndmask_b32_dpp v157, v153, v149, vcc quad_perm:[2,3,0,1] row_mask:0xf bank_mask:0xf
    v_cndmask_b32_dpp v158, v154, v150, vcc quad_perm:[2,3,0,1] row_mask:0xf bank_mask:0xf
    v_cndmask_b32_dpp v159, v155, v151, vcc quad_perm:[2,3,0,1] row_mask:0xf bank_mask:0xf
    s_not_b64 vcc, vcc
    v_cndmask_b32_dpp v160, v148, v152, vcc quad_perm:[2,3,0,1] row_mask:0xf bank_mask:0xf
    v_cndmask_b32_dpp v161, v149, v153, vcc quad_perm:[2,3,0,1] row_mask:0xf bank_mask:0xf
    v_cndmask_b32_dpp v162, v150, v154, vcc quad_perm:[2,3,0,1] row_mask:0xf bank_mask:0xf
    v_cndmask_b32_dpp v163, v151, v155, vcc quad_perm:[2,3,0,1] row_mask:0xf bank_mask:0xf
    buffer_store_dwordx4 v[156:159], v78, s[20:23], s74 offen sc1
    buffer_store_dwordx4 v[160:163], v78, s[20:23], s75 offen sc1
    s_mov_b64 exec, 3
    buffer_store_dwordx4 v[32:35], v3, s[20:23], s83 offen sc1
    s_mov_b64 exec, -1
    s_mov_b64 exec, 0xffff
    buffer_store_dwordx4 v[36:39], v3, s[20:23], s76 offen sc1
    s_mov_b64 exec, -1
    s_bitcmp1_b32 0xc888, s53
    s_cbranch_scc1 M_G1L
    s_barrier
    ds_read_b128 v[148:151], v66 offset:0
    ds_read_b64_tr_b16 v[156:157], v70 offset:0
    ds_read_b64_tr_b16 v[158:159], v70 offset:768
    ds_read_b128 v[152:155], v66 offset:2048
    ds_read_b64_tr_b16 v[160:161], v71 offset:0
    ds_read_b64_tr_b16 v[162:163], v71 offset:768
    ds_read_b64_tr_b16 v[164:165], v70 offset:256
    ds_read_b64_tr_b16 v[166:167], v70 offset:1024
    ds_read_b64_tr_b16 v[168:169], v71 offset:256
    ds_read_b64_tr_b16 v[170:171], v71 offset:1024
    ds_read_b64_tr_b16 v[172:173], v70 offset:512
    ds_read_b64_tr_b16 v[174:175], v70 offset:1280
    ds_read_b64_tr_b16 v[176:177], v71 offset:512
    ds_read_b64_tr_b16 v[178:179], v71 offset:1280
    s_waitcnt lgkmcnt(11)
    v_mfma_f32_16x16x32_bf16 v[88:91], v[156:159], v[148:151], 0
    ds_read_b128 v[180:183], v67 offset:0
    s_waitcnt lgkmcnt(11)
    v_mfma_f32_16x16x32_bf16 v[96:99], v[156:159], v[152:155], 0
    ds_read_b64_tr_b16 v[188:189], v72 offset:0
    ds_read_b64_tr_b16 v[190:191], v72 offset:768
    s_waitcnt lgkmcnt(11)
    v_mfma_f32_16x16x32_bf16 v[92:95], v[160:163], v[148:151], 0
    ds_read_b128 v[184:187], v67 offset:2048
    v_mfma_f32_16x16x32_bf16 v[100:103], v[160:163], v[152:155], 0
    ds_read_b64_tr_b16 v[192:193], v73 offset:0
    ds_read_b64_tr_b16 v[194:195], v73 offset:768
    s_waitcnt lgkmcnt(12)
    v_mfma_f32_16x16x32_bf16 v[104:107], v[164:167], v[148:151], 0
    ds_read_b64_tr_b16 v[196:197], v72 offset:256
    v_mfma_f32_16x16x32_bf16 v[112:115], v[164:167], v[152:155], 0
    ds_read_b64_tr_b16 v[198:199], v72 offset:1024
    s_waitcnt lgkmcnt(12)
    v_mfma_f32_16x16x32_bf16 v[108:111], v[168:171], v[148:151], 0
    ds_read_b64_tr_b16 v[200:201], v73 offset:256
    v_mfma_f32_16x16x32_bf16 v[116:119], v[168:171], v[152:155], 0
    ds_read_b64_tr_b16 v[202:203], v73 offset:1024
    s_waitcnt lgkmcnt(12)
    v_mfma_f32_16x16x32_bf16 v[120:123], v[172:175], v[148:151], 0
    ds_read_b64_tr_b16 v[204:205], v72 offset:512
    v_mfma_f32_16x16x32_bf16 v[128:131], v[172:175], v[152:155], 0
    ds_read_b64_tr_b16 v[206:207], v72 offset:1280
    s_waitcnt lgkmcnt(12)
    v_mfma_f32_16x16x32_bf16 v[124:127], v[176:179], v[148:151], 0
    ds_read_b64_tr_b16 v[208:209], v73 offset:512
    v_mfma_f32_16x16x32_bf16 v[132:135], v[176:179], v[152:155], 0
    ds_read_b64_tr_b16 v[210:211], v73 offset:1280
    s_bitcmp1_b32 s3, 1
    s_cbranch_scc1 M_CS1
    v_mfma_f32_16x16x32_bf16 v[136:139], v[80:83], v[156:159], 0
    v_mfma_f32_16x16x32_bf16 v[140:143], v[80:83], v[160:163], 0
    v_mfma_f32_16x16x32_bf16 v[144:147], v[80:83], v[164:167], 0
    s_branch M_CS2
M_CS1:
    v_mfma_f32_16x16x32_bf16 v[136:139], v[80:83], v[168:171], 0
    v_mfma_f32_16x16x32_bf16 v[140:143], v[80:83], v[172:175], 0
    v_mfma_f32_16x16x32_bf16 v[144:147], v[80:83], v[176:179], 0
M_CS2:
    s_waitcnt lgkmcnt(6)
    v_mfma_f32_16x16x32_bf16 v[88:91], v[188:191], v[180:183], v[88:91]
    s_waitcnt vmcnt(2)
    s_waitcnt lgkmcnt(0)
    s_barrier
    s_cmp_lg_u32 s3, 0
    s_cbranch_scc1 M_A3
    s_mov_b64 exec, 0xff
    buffer_store_dwordx4 v[12:15], v3, s[20:23], s64 offen sc1
    s_mov_b64 exec, -1
M_A3:
    ds_read_b128 v[148:151], v66 offset:28672
    v_mfma_f32_16x16x32_bf16 v[96:99], v[188:191], v[184:187], v[96:99]
    ds_read_b64_tr_b16 v[156:157], v70 offset:28672
    ds_read_b64_tr_b16 v[158:159], v70 offset:29440
    v_mfma_f32_16x16x32_bf16 v[92:95], v[192:195], v[180:183], v[92:95]
    ds_read_b128 v[152:155], v66 offset:30720
    v_mfma_f32_16x16x32_bf16 v[100:103], v[192:195], v[184:187], v[100:103]
    ds_read_b64_tr_b16 v[160:161], v71 offset:28672
    ds_read_b64_tr_b16 v[162:163], v71 offset:29440
    v_mfma_f32_16x16x32_bf16 v[104:107], v[196:199], v[180:183], v[104:107]
    ds_read_b64_tr_b16 v[164:165], v70 offset:28928
    v_mfma_f32_16x16x32_bf16 v[112:115], v[196:199], v[184:187], v[112:115]
    ds_read_b64_tr_b16 v[166:167], v70 offset:29696
    v_mfma_f32_16x16x32_bf16 v[108:111], v[200:203], v[180:183], v[108:111]
    ds_read_b64_tr_b16 v[168:169], v71 offset:28928
    v_mfma_f32_16x16x32_bf16 v[116:119], v[200:203], v[184:187], v[116:119]
    ds_read_b64_tr_b16 v[170:171], v71 offset:29696
    v_mfma_f32_16x16x32_bf16 v[120:123], v[204:207], v[180:183], v[120:123]
    ds_read_b64_tr_b16 v[172:173], v70 offset:29184
    v_mfma_f32_16x16x32_bf16 v[128:131], v[204:207], v[184:187], v[128:131]
    ds_read_b64_tr_b16 v[174:175], v70 offset:29952
    v_mfma_f32_16x16x32_bf16 v[124:127], v[208:211], v[180:183], v[124:127]
    ds_read_b64_tr_b16 v[176:177], v71 offset:29184
    v_mfma_f32_16x16x32_bf16 v[132:135], v[208:211], v[184:187], v[132:135]
    ds_read_b64_tr_b16 v[178:179], v71 offset:29952
    s_waitcnt lgkmcnt(6)
    v_mfma_f32_16x16x32_bf16 v[88:91], v[156:159], v[148:151], v[88:91]
    ds_read_b128 v[180:183], v67 offset:28672
    v_mfma_f32_16x16x32_bf16 v[96:99], v[156:159], v[152:155], v[96:99]
    ds_read_b64_tr_b16 v[188:189], v72 offset:28672
    ds_read_b64_tr_b16 v[190:191], v72 offset:29440
    v_mfma_f32_16x16x32_bf16 v[92:95], v[160:163], v[148:151], v[92:95]
    ds_read_b128 v[184:187], v67 offset:30720
    v_mfma_f32_16x16x32_bf16 v[100:103], v[160:163], v[152:155], v[100:103]
    ds_read_b64_tr_b16 v[192:193], v73 offset:28672
    ds_read_b64_tr_b16 v[194:195], v73 offset:29440
    v_mfma_f32_16x16x32_bf16 v[104:107], v[164:167], v[148:151], v[104:107]
    ds_read_b64_tr_b16 v[196:197], v72 offset:28928
    v_mfma_f32_16x16x32_bf16 v[112:115], v[164:167], v[152:155], v[112:115]
    ds_read_b64_tr_b16 v[198:199], v72 offset:29696
    s_waitcnt lgkmcnt(8)
    v_mfma_f32_16x16x32_bf16 v[108:111], v[168:171], v[148:151], v[108:111]
    ds_read_b64_tr_b16 v[200:201], v73 offset:28928
    v_mfma_f32_16x16x32_bf16 v[116:119], v[168:171], v[152:155], v[116:119]
    ds_read_b64_tr_b16 v[202:203], v73 offset:29696
    v_mfma_f32_16x16x32_bf16 v[120:123], v[172:175], v[148:151], v[120:123]
    ds_read_b64_tr_b16 v[204:205], v72 offset:29184
    v_mfma_f32_16x16x32_bf16 v[128:131], v[172:175], v[152:155], v[128:131]
    ds_read_b64_tr_b16 v[206:207], v72 offset:29952
    v_mfma_f32_16x16x32_bf16 v[124:127], v[176:179], v[148:151], v[124:127]
    ds_read_b64_tr_b16 v[208:209], v73 offset:29184
    v_mfma_f32_16x16x32_bf16 v[132:135], v[176:179], v[152:155], v[132:135]
    ds_read_b64_tr_b16 v[210:211], v73 offset:29952
    s_bitcmp1_b32 s3, 1
    s_cbranch_scc1 M_CS4
    v_mfma_f32_16x16x32_bf16 v[136:139], v[80:83], v[156:159], v[136:139]
    v_mfma_f32_16x16x32_bf16 v[140:143], v[80:83], v[160:163], v[140:143]
    v_mfma_f32_16x16x32_bf16 v[144:147], v[80:83], v[164:167], v[144:147]
    s_branch M_CS5
M_CS4:
    v_mfma_f32_16x16x32_bf16 v[136:139], v[80:83], v[168:171], v[136:139]
    v_mfma_f32_16x16x32_bf16 v[140:143], v[80:83], v[172:175], v[140:143]
    v_mfma_f32_16x16x32_bf16 v[144:147], v[80:83], v[176:179], v[144:147]
M_CS5:
    s_waitcnt lgkmcnt(6)
    v_mfma_f32_16x16x32_bf16 v[88:91], v[188:191], v[180:183], v[88:91]
    s_waitcnt lgkmcnt(0)
    s_barrier
    ds_read_b128 v[148:151], v68 offset:0
    v_mfma_f32_16x16x32_bf16 v[96:99], v[188:191], v[184:187], v[96:99]
    ds_read_b64_tr_b16 v[156:157], v74 offset:0
    ds_read_b64_tr_b16 v[158:159], v74 offset:768
    v_mfma_f32_16x16x32_bf16 v[92:95], v[192:195], v[180:183], v[92:95]
    ds_read_b128 v[152:155], v68 offset:2048
    v_mfma_f32_16x16x32_bf16 v[100:103], v[192:195], v[184:187], v[100:103]
    ds_read_b64_tr_b16 v[160:161], v75 offset:0
    ds_read_b64_tr_b16 v[162:163], v75 offset:768
    v_mfma_f32_16x16x32_bf16 v[104:107], v[196:199], v[180:183], v[104:107]
    ds_read_b64_tr_b16 v[164:165], v74 offset:256
    v_mfma_f32_16x16x32_bf16 v[112:115], v[196:199], v[184:187], v[112:115]
    ds_read_b64_tr_b16 v[166:167], v74 offset:1024
    v_mfma_f32_16x16x32_bf16 v[108:111], v[200:203], v[180:183], v[108:111]
    ds_read_b64_tr_b16 v[168:169], v75 offset:256
    v_mfma_f32_16x16x32_bf16 v[116:119], v[200:203], v[184:187], v[116:119]
    ds_read_b64_tr_b16 v[170:171], v75 offset:1024
    v_mfma_f32_16x16x32_bf16 v[120:123], v[204:207], v[180:183], v[120:123]
    ds_read_b64_tr_b16 v[172:173], v74 offset:512
    v_mfma_f32_16x16x32_bf16 v[128:131], v[204:207], v[184:187], v[128:131]
    ds_read_b64_tr_b16 v[174:175], v74 offset:1280
    v_mfma_f32_16x16x32_bf16 v[124:127], v[208:211], v[180:183], v[124:127]
    ds_read_b64_tr_b16 v[176:177], v75 offset:512
    v_mfma_f32_16x16x32_bf16 v[132:135], v[208:211], v[184:187], v[132:135]
    ds_read_b64_tr_b16 v[178:179], v75 offset:1280
    s_waitcnt lgkmcnt(6)
    v_mfma_f32_16x16x32_bf16 v[88:91], v[156:159], v[148:151], v[88:91]
    ds_read_b128 v[180:183], v69 offset:0
    v_mfma_f32_16x16x32_bf16 v[96:99], v[156:159], v[152:155], v[96:99]
    ds_read_b64_tr_b16 v[188:189], v76 offset:0
    ds_read_b64_tr_b16 v[190:191], v76 offset:768
    v_mfma_f32_16x16x32_bf16 v[92:95], v[160:163], v[148:151], v[92:95]
    ds_read_b128 v[184:187], v69 offset:2048
    v_mfma_f32_16x16x32_bf16 v[100:103], v[160:163], v[152:155], v[100:103]
    ds_read_b64_tr_b16 v[192:193], v77 offset:0
    ds_read_b64_tr_b16 v[194:195], v77 offset:768
    v_mfma_f32_16x16x32_bf16 v[104:107], v[164:167], v[148:151], v[104:107]
    ds_read_b64_tr_b16 v[196:197], v76 offset:256
    v_mfma_f32_16x16x32_bf16 v[112:115], v[164:167], v[152:155], v[112:115]
    ds_read_b64_tr_b16 v[198:199], v76 offset:1024
    s_waitcnt lgkmcnt(8)
    v_mfma_f32_16x16x32_bf16 v[108:111], v[168:171], v[148:151], v[108:111]
    ds_read_b64_tr_b16 v[200:201], v77 offset:256
    v_mfma_f32_16x16x32_bf16 v[116:119], v[168:171], v[152:155], v[116:119]
    ds_read_b64_tr_b16 v[202:203], v77 offset:1024
    v_mfma_f32_16x16x32_bf16 v[120:123], v[172:175], v[148:151], v[120:123]
    ds_read_b64_tr_b16 v[204:205], v76 offset:512
    v_mfma_f32_16x16x32_bf16 v[128:131], v[172:175], v[152:155], v[128:131]
    ds_read_b64_tr_b16 v[206:207], v76 offset:1280
    v_mfma_f32_16x16x32_bf16 v[124:127], v[176:179], v[148:151], v[124:127]
    ds_read_b64_tr_b16 v[208:209], v77 offset:512
    v_mfma_f32_16x16x32_bf16 v[132:135], v[176:179], v[152:155], v[132:135]
    ds_read_b64_tr_b16 v[210:211], v77 offset:1280
    s_bitcmp1_b32 s3, 1
    s_cbranch_scc1 M_CS6
    v_mfma_f32_16x16x32_bf16 v[136:139], v[80:83], v[156:159], v[136:139]
    v_mfma_f32_16x16x32_bf16 v[140:143], v[80:83], v[160:163], v[140:143]
    v_mfma_f32_16x16x32_bf16 v[144:147], v[80:83], v[164:167], v[144:147]
    s_branch M_CS7
M_CS6:
    v_mfma_f32_16x16x32_bf16 v[136:139], v[80:83], v[168:171], v[136:139]
    v_mfma_f32_16x16x32_bf16 v[140:143], v[80:83], v[172:175], v[140:143]
    v_mfma_f32_16x16x32_bf16 v[144:147], v[80:83], v[176:179], v[144:147]
M_CS7:
    s_waitcnt lgkmcnt(6)
    v_mfma_f32_16x16x32_bf16 v[88:91], v[188:191], v[180:183], v[88:91]
    s_waitcnt lgkmcnt(0)
    s_barrier
    ds_read_b128 v[148:151], v68 offset:28672
    v_mfma_f32_16x16x32_bf16 v[96:99], v[188:191], v[184:187], v[96:99]
    ds_read_b64_tr_b16 v[156:157], v74 offset:28672
    ds_read_b64_tr_b16 v[158:159], v74 offset:29440
    v_mfma_f32_16x16x32_bf16 v[92:95], v[192:195], v[180:183], v[92:95]
    ds_read_b128 v[152:155], v68 offset:30720
    v_mfma_f32_16x16x32_bf16 v[100:103], v[192:195], v[184:187], v[100:103]
    ds_read_b64_tr_b16 v[160:161], v75 offset:28672
    ds_read_b64_tr_b16 v[162:163], v75 offset:29440
    v_mfma_f32_16x16x32_bf16 v[104:107], v[196:199], v[180:183], v[104:107]
    ds_read_b64_tr_b16 v[164:165], v74 offset:28928
    v_mfma_f32_16x16x32_bf16 v[112:115], v[196:199], v[184:187], v[112:115]
    ds_read_b64_tr_b16 v[166:167], v74 offset:29696
    v_mfma_f32_16x16x32_bf16 v[108:111], v[200:203], v[180:183], v[108:111]
    ds_read_b64_tr_b16 v[168:169], v75 offset:28928
    v_mfma_f32_16x16x32_bf16 v[116:119], v[200:203], v[184:187], v[116:119]
    ds_read_b64_tr_b16 v[170:171], v75 offset:29696
    v_mfma_f32_16x16x32_bf16 v[120:123], v[204:207], v[180:183], v[120:123]
    ds_read_b64_tr_b16 v[172:173], v74 offset:29184
    v_mfma_f32_16x16x32_bf16 v[128:131], v[204:207], v[184:187], v[128:131]
    ds_read_b64_tr_b16 v[174:175], v74 offset:29952
    v_mfma_f32_16x16x32_bf16 v[124:127], v[208:211], v[180:183], v[124:127]
    ds_read_b64_tr_b16 v[176:177], v75 offset:29184
    v_mfma_f32_16x16x32_bf16 v[132:135], v[208:211], v[184:187], v[132:135]
    ds_read_b64_tr_b16 v[178:179], v75 offset:29952
    s_waitcnt lgkmcnt(6)
    v_mfma_f32_16x16x32_bf16 v[88:91], v[156:159], v[148:151], v[88:91]
    ds_read_b128 v[180:183], v69 offset:28672
    v_and_b32 v8, 15, v1
    v_mfma_f32_16x16x32_bf16 v[96:99], v[156:159], v[152:155], v[96:99]
    ds_read_b64_tr_b16 v[188:189], v76 offset:28672
    ds_read_b64_tr_b16 v[190:191], v76 offset:29440
    v_mfma_f32_16x16x32_bf16 v[92:95], v[160:163], v[148:151], v[92:95]
    ds_read_b128 v[184:187], v69 offset:30720
    v_lshlrev_b32 v8, 1, v8
    v_mfma_f32_16x16x32_bf16 v[100:103], v[160:163], v[152:155], v[100:103]
    ds_read_b64_tr_b16 v[192:193], v77 offset:28672
    ds_read_b64_tr_b16 v[194:195], v77 offset:29440
    v_mfma_f32_16x16x32_bf16 v[104:107], v[164:167], v[148:151], v[104:107]
    ds_read_b64_tr_b16 v[196:197], v76 offset:28928
    v_add_u32 v8, 160064, v8
    v_mfma_f32_16x16x32_bf16 v[112:115], v[164:167], v[152:155], v[112:115]
    ds_read_b64_tr_b16 v[198:199], v76 offset:29696
    ds_read_u16 v42, v8 offset:0
    s_waitcnt lgkmcnt(9)
    v_mfma_f32_16x16x32_bf16 v[108:111], v[168:171], v[148:151], v[108:111]
    ds_read_b64_tr_b16 v[200:201], v77 offset:28928
    v_mov_b32 v43, 0
    v_mfma_f32_16x16x32_bf16 v[116:119], v[168:171], v[152:155], v[116:119]
    ds_read_b64_tr_b16 v[202:203], v77 offset:29696
    ds_read_u16 v46, v8 offset:32
    v_mfma_f32_16x16x32_bf16 v[120:123], v[172:175], v[148:151], v[120:123]
    ds_read_b64_tr_b16 v[204:205], v76 offset:29184
    v_mov_b32 v47, 0
    v_mfma_f32_16x16x32_bf16 v[128:131], v[172:175], v[152:155], v[128:131]
    ds_read_b64_tr_b16 v[206:207], v76 offset:29952
    ds_read_u16 v50, v8 offset:64
    v_mfma_f32_16x16x32_bf16 v[124:127], v[176:179], v[148:151], v[124:127]
    ds_read_b64_tr_b16 v[208:209], v77 offset:29184
    v_mov_b32 v51, 0
    v_mfma_f32_16x16x32_bf16 v[132:135], v[176:179], v[152:155], v[132:135]
    ds_read_b64_tr_b16 v[210:211], v77 offset:29952
    s_bitcmp1_b32 s3, 1
    s_cbranch_scc1 M_CS8
    v_mfma_f32_16x16x32_bf16 v[136:139], v[80:83], v[156:159], v[136:139]
    v_mfma_f32_16x16x32_bf16 v[140:143], v[80:83], v[160:163], v[140:143]
    v_mfma_f32_16x16x32_bf16 v[144:147], v[80:83], v[164:167], v[144:147]
    s_branch M_CS9
M_CS8:
    v_mfma_f32_16x16x32_bf16 v[136:139], v[80:83], v[168:171], v[136:139]
    v_mfma_f32_16x16x32_bf16 v[140:143], v[80:83], v[172:175], v[140:143]
    v_mfma_f32_16x16x32_bf16 v[144:147], v[80:83], v[176:179], v[144:147]
M_CS9:
    s_waitcnt lgkmcnt(9)
    v_mfma_f32_16x16x32_bf16 v[88:91], v[188:191], v[180:183], v[88:91]
    ds_read_u16 v54, v8 offset:96
    v_mov_b32 v55, 0
    ds_read_u16 v58, v8 offset:128
    v_mov_b32 v59, 0
    s_waitcnt lgkmcnt(0)
    s_barrier
    buffer_load_dwordx4 v[36:39], v79, s[20:23], s62 offen sc1
    buffer_load_dword v27, v86, s[20:23], s63 offen sc1
    ds_read_b128 v[148:151], v66 offset:0
    ds_read_u16 v62, v8 offset:160
    v_mfma_f32_16x16x32_bf16 v[96:99], v[188:191], v[184:187], v[96:99]
    ds_read_b64_tr_b16 v[156:157], v70 offset:0
    ds_read_b64_tr_b16 v[158:159], v70 offset:768
    v_mfma_f32_16x16x32_bf16 v[92:95], v[192:195], v[180:183], v[92:95]
    ds_read_b128 v[152:155], v66 offset:2048
    v_mov_b32 v63, 0
    v_mfma_f32_16x16x32_bf16 v[100:103], v[192:195], v[184:187], v[100:103]
    ds_read_b64_tr_b16 v[160:161], v71 offset:0
    ds_read_b64_tr_b16 v[162:163], v71 offset:768
    v_mfma_f32_16x16x32_bf16 v[104:107], v[196:199], v[180:183], v[104:107]
    ds_read_b64_tr_b16 v[164:165], v70 offset:256
    v_lshl_or_b32 v42, v42, 16, v42
    v_mfma_f32_16x16x32_bf16 v[112:115], v[196:199], v[184:187], v[112:115]
    ds_read_b64_tr_b16 v[166:167], v70 offset:1024
    v_lshl_or_b32 v46, v46, 16, v46
    v_mfma_f32_16x16x32_bf16 v[108:111], v[200:203], v[180:183], v[108:111]
    ds_read_b64_tr_b16 v[168:169], v71 offset:256
    v_lshl_or_b32 v50, v50, 16, v50
    v_mfma_f32_16x16x32_bf16 v[116:119], v[200:203], v[184:187], v[116:119]
    ds_read_b64_tr_b16 v[170:171], v71 offset:1024
    v_lshl_or_b32 v54, v54, 16, v54
    v_mfma_f32_16x16x32_bf16 v[120:123], v[204:207], v[180:183], v[120:123]
    ds_read_b64_tr_b16 v[172:173], v70 offset:512
    v_lshl_or_b32 v58, v58, 16, v58
    v_mfma_f32_16x16x32_bf16 v[128:131], v[204:207], v[184:187], v[128:131]
    ds_read_b64_tr_b16 v[174:175], v70 offset:1280
    s_waitcnt lgkmcnt(11)
    v_lshl_or_b32 v62, v62, 16, v62
    v_mfma_f32_16x16x32_bf16 v[124:127], v[208:211], v[180:183], v[124:127]
    ds_read_b64_tr_b16 v[176:177], v71 offset:512
    v_mfma_f32_16x16x32_bf16 v[132:135], v[208:211], v[184:187], v[132:135]
    ds_read_b64_tr_b16 v[178:179], v71 offset:1280
    s_waitcnt lgkmcnt(6)
    v_mfma_f32_16x16x32_bf16 v[88:91], v[156:159], v[148:151], v[88:91]
    ds_read_b128 v[180:183], v67 offset:0
    v_mfma_f32_16x16x32_bf16 v[96:99], v[156:159], v[152:155], v[96:99]
    ds_read_b64_tr_b16 v[188:189], v72 offset:0
    ds_read_b64_tr_b16 v[190:191], v72 offset:768
    v_mfma_f32_16x16x32_bf16 v[92:95], v[160:163], v[148:151], v[92:95]
    ds_read_b128 v[184:187], v67 offset:2048
    v_mfma_f32_16x16x32_bf16 v[100:103], v[160:163], v[152:155], v[100:103]
    ds_read_b64_tr_b16 v[192:193], v73 offset:0
    ds_read_b64_tr_b16 v[194:195], v73 offset:768
    v_mfma_f32_16x16x32_bf16 v[104:107], v[164:167], v[148:151], v[104:107]
    ds_read_b64_tr_b16 v[196:197], v72 offset:256
    v_mfma_f32_16x16x32_bf16 v[112:115], v[164:167], v[152:155], v[112:115]
    ds_read_b64_tr_b16 v[198:199], v72 offset:1024
    s_waitcnt lgkmcnt(8)
    v_mfma_f32_16x16x32_bf16 v[108:111], v[168:171], v[148:151], v[108:111]
    ds_read_b64_tr_b16 v[200:201], v73 offset:256
    v_mfma_f32_16x16x32_bf16 v[116:119], v[168:171], v[152:155], v[116:119]
    ds_read_b64_tr_b16 v[202:203], v73 offset:1024
    v_mfma_f32_16x16x32_bf16 v[120:123], v[172:175], v[148:151], v[120:123]
    ds_read_b64_tr_b16 v[204:205], v72 offset:512
    v_mfma_f32_16x16x32_bf16 v[128:131], v[172:175], v[152:155], v[128:131]
    ds_read_b64_tr_b16 v[206:207], v72 offset:1280
    v_mfma_f32_16x16x32_bf16 v[124:127], v[176:179], v[148:151], v[124:127]
    ds_read_b64_tr_b16 v[208:209], v73 offset:512
    v_mfma_f32_16x16x32_bf16 v[132:135], v[176:179], v[152:155], v[132:135]
    ds_read_b64_tr_b16 v[210:211], v73 offset:1280
    s_bitcmp1_b32 s3, 1
    s_cbranch_scc1 M_CS10
    v_mfma_f32_16x16x32_bf16 v[136:139], v[80:83], v[156:159], v[136:139]
    v_mfma_f32_16x16x32_bf16 v[140:143], v[80:83], v[160:163], v[140:143]
    v_mfma_f32_16x16x32_bf16 v[144:147], v[80:83], v[164:167], v[144:147]
    s_branch M_CS11
M_CS10:
    v_mfma_f32_16x16x32_bf16 v[136:139], v[80:83], v[168:171], v[136:139]
    v_mfma_f32_16x16x32_bf16 v[140:143], v[80:83], v[172:175], v[140:143]
    v_mfma_f32_16x16x32_bf16 v[144:147], v[80:83], v[176:179], v[144:147]
M_CS11:
    s_waitcnt lgkmcnt(6)
    v_mfma_f32_16x16x32_bf16 v[88:91], v[188:191], v[180:183], v[88:91]
    s_waitcnt lgkmcnt(0)
    s_barrier
    ds_read_b128 v[148:151], v66 offset:28672
    v_mfma_f32_16x16x32_bf16 v[96:99], v[188:191], v[184:187], v[96:99]
    ds_read_b64_tr_b16 v[156:157], v70 offset:28672
    ds_read_b64_tr_b16 v[158:159], v70 offset:29440
    v_mfma_f32_16x16x32_bf16 v[92:95], v[192:195], v[180:183], v[92:95]
    ds_read_b128 v[152:155], v66 offset:30720
    v_mfma_f32_16x16x32_bf16 v[100:103], v[192:195], v[184:187], v[100:103]
    ds_read_b64_tr_b16 v[160:161], v71 offset:28672
    ds_read_b64_tr_b16 v[162:163], v71 offset:29440
    v_mfma_f32_16x16x32_bf16 v[104:107], v[196:199], v[180:183], v[104:107]
    ds_read_b64_tr_b16 v[164:165], v70 offset:28928
    v_mfma_f32_16x16x32_bf16 v[112:115], v[196:199], v[184:187], v[112:115]
    ds_read_b64_tr_b16 v[166:167], v70 offset:29696
    v_mfma_f32_16x16x32_bf16 v[108:111], v[200:203], v[180:183], v[108:111]
    ds_read_b64_tr_b16 v[168:169], v71 offset:28928
    v_mfma_f32_16x16x32_bf16 v[116:119], v[200:203], v[184:187], v[116:119]
    ds_read_b64_tr_b16 v[170:171], v71 offset:29696
    v_mfma_f32_16x16x32_bf16 v[120:123], v[204:207], v[180:183], v[120:123]
    ds_read_b64_tr_b16 v[172:173], v70 offset:29184
    v_mfma_f32_16x16x32_bf16 v[128:131], v[204:207], v[184:187], v[128:131]
    ds_read_b64_tr_b16 v[174:175], v70 offset:29952
    v_mfma_f32_16x16x32_bf16 v[124:127], v[208:211], v[180:183], v[124:127]
    ds_read_b64_tr_b16 v[176:177], v71 offset:29184
    v_mfma_f32_16x16x32_bf16 v[132:135], v[208:211], v[184:187], v[132:135]
    ds_read_b64_tr_b16 v[178:179], v71 offset:29952
    s_waitcnt lgkmcnt(6)
    v_mfma_f32_16x16x32_bf16 v[88:91], v[156:159], v[148:151], v[88:91]
    ds_read_b128 v[180:183], v67 offset:28672
    v_mfma_f32_16x16x32_bf16 v[96:99], v[156:159], v[152:155], v[96:99]
    ds_read_b64_tr_b16 v[188:189], v72 offset:28672
    ds_read_b64_tr_b16 v[190:191], v72 offset:29440
    v_mfma_f32_16x16x32_bf16 v[92:95], v[160:163], v[148:151], v[92:95]
    ds_read_b128 v[184:187], v67 offset:30720
    v_mfma_f32_16x16x32_bf16 v[100:103], v[160:163], v[152:155], v[100:103]
    ds_read_b64_tr_b16 v[192:193], v73 offset:28672
    ds_read_b64_tr_b16 v[194:195], v73 offset:29440
    v_mfma_f32_16x16x32_bf16 v[104:107], v[164:167], v[148:151], v[104:107]
    ds_read_b64_tr_b16 v[196:197], v72 offset:28928
    v_mfma_f32_16x16x32_bf16 v[112:115], v[164:167], v[152:155], v[112:115]
    ds_read_b64_tr_b16 v[198:199], v72 offset:29696
    s_waitcnt lgkmcnt(8)
    v_mfma_f32_16x16x32_bf16 v[108:111], v[168:171], v[148:151], v[108:111]
    ds_read_b64_tr_b16 v[200:201], v73 offset:28928
    v_mfma_f32_16x16x32_bf16 v[116:119], v[168:171], v[152:155], v[116:119]
    ds_read_b64_tr_b16 v[202:203], v73 offset:29696
    v_mfma_f32_16x16x32_bf16 v[120:123], v[172:175], v[148:151], v[120:123]
    ds_read_b64_tr_b16 v[204:205], v72 offset:29184
    v_mfma_f32_16x16x32_bf16 v[128:131], v[172:175], v[152:155], v[128:131]
    ds_read_b64_tr_b16 v[206:207], v72 offset:29952
    v_mfma_f32_16x16x32_bf16 v[124:127], v[176:179], v[148:151], v[124:127]
    ds_read_b64_tr_b16 v[208:209], v73 offset:29184
    v_mfma_f32_16x16x32_bf16 v[132:135], v[176:179], v[152:155], v[132:135]
    ds_read_b64_tr_b16 v[210:211], v73 offset:29952
    s_bitcmp1_b32 s3, 1
    s_cbranch_scc1 M_CS12
    v_mfma_f32_16x16x32_bf16 v[136:139], v[80:83], v[156:159], v[136:139]
    v_mfma_f32_16x16x32_bf16 v[140:143], v[80:83], v[160:163], v[140:143]
    v_mfma_f32_16x16x32_bf16 v[144:147], v[80:83], v[164:167], v[144:147]
    s_branch M_CS13
M_CS12:
    v_mfma_f32_16x16x32_bf16 v[136:139], v[80:83], v[168:171], v[136:139]
    v_mfma_f32_16x16x32_bf16 v[140:143], v[80:83], v[172:175], v[140:143]
    v_mfma_f32_16x16x32_bf16 v[144:147], v[80:83], v[176:179], v[144:147]
M_CS13:
    s_mov_b32 s65, 0
    s_waitcnt vmcnt(0)
M_STCHK:
    v_xor_b32 v8, v37, v4
    v_xor_b32 v9, v39, v4
    v_xor_b32 v10, v27, v4
    v_or3_b32 v8, v8, v9, v10
    v_cmp_ne_u32 vcc, 0, v8
    s_cbranch_vccnz M_STRETRY
M_STOK:
    s_waitcnt lgkmcnt(6)
    v_mfma_f32_16x16x32_bf16 v[88:91], v[188:191], v[180:183], v[88:91]
    v_add_f32 v8, 0x3727c5ac, v38
    v_rsq_f32 v85, v8
    v_mov_b32 v215, 0
    v_mul_f32 v9, v85, v85
    s_waitcnt lgkmcnt(0)
    s_barrier
    ds_read_b128 v[148:151], v68 offset:0
    v_mul_f32 v9, v9, v38
    v_mfma_f32_16x16x32_bf16 v[96:99], v[188:191], v[184:187], v[96:99]
    ds_read_b64_tr_b16 v[156:157], v74 offset:0
    ds_read_b64_tr_b16 v[158:159], v74 offset:768
    v_mfma_f32_16x16x32_bf16 v[92:95], v[192:195], v[180:183], v[92:95]
    ds_read_b128 v[152:155], v68 offset:2048
    v_add_f32 v9, 0x3727c5ac, v9
    v_mfma_f32_16x16x32_bf16 v[100:103], v[192:195], v[184:187], v[100:103]
    ds_read_b64_tr_b16 v[160:161], v75 offset:0
    ds_read_b64_tr_b16 v[162:163], v75 offset:768
    v_mfma_f32_16x16x32_bf16 v[104:107], v[196:199], v[180:183], v[104:107]
    ds_read_b64_tr_b16 v[164:165], v74 offset:256
    v_rsq_f32 v9, v9
    v_mfma_f32_16x16x32_bf16 v[112:115], v[196:199], v[184:187], v[112:115]
    ds_read_b64_tr_b16 v[166:167], v74 offset:1024
    v_mov_b32 v219, 0
    v_mfma_f32_16x16x32_bf16 v[108:111], v[200:203], v[180:183], v[108:111]
    ds_read_b64_tr_b16 v[168:169], v75 offset:256
    v_mul_f32 v9, v9, v85
    v_mfma_f32_16x16x32_bf16 v[116:119], v[200:203], v[184:187], v[116:119]
    ds_read_b64_tr_b16 v[170:171], v75 offset:1024
    v_rcp_f32 v222, v9
    v_mfma_f32_16x16x32_bf16 v[120:123], v[204:207], v[180:183], v[120:123]
    ds_read_b64_tr_b16 v[172:173], v74 offset:512
    v_mul_f32 v226, 0xc0135761, v9
    v_mfma_f32_16x16x32_bf16 v[128:131], v[204:207], v[184:187], v[128:131]
    ds_read_b64_tr_b16 v[174:175], v74 offset:1280
    v_mul_f32 v8, v9, v9
    v_mfma_f32_16x16x32_bf16 v[124:127], v[208:211], v[180:183], v[124:127]
    ds_read_b64_tr_b16 v[176:177], v75 offset:512
    v_mul_f32 v8, 0x3d372713, v8
    v_mfma_f32_16x16x32_bf16 v[132:135], v[208:211], v[184:187], v[132:135]
    ds_read_b64_tr_b16 v[178:179], v75 offset:1280
    v_mul_f32 v64, v8, v226
    s_waitcnt lgkmcnt(6)
    v_mfma_f32_16x16x32_bf16 v[88:91], v[156:159], v[148:151], v[88:91]
    ds_read_b128 v[180:183], v69 offset:0
    v_cvt_pk_bf16_f32 v8, -v36, v222
    v_mfma_f32_16x16x32_bf16 v[96:99], v[156:159], v[152:155], v[96:99]
    ds_read_b64_tr_b16 v[188:189], v76 offset:0
    ds_read_b64_tr_b16 v[190:191], v76 offset:768
    v_mfma_f32_16x16x32_bf16 v[92:95], v[160:163], v[148:151], v[92:95]
    ds_read_b128 v[184:187], v69 offset:2048
    v_lshlrev_b32 v9, 16, v8
    v_mfma_f32_16x16x32_bf16 v[100:103], v[160:163], v[152:155], v[100:103]
    ds_read_b64_tr_b16 v[192:193], v77 offset:0
    ds_read_b64_tr_b16 v[194:195], v77 offset:768
    v_mfma_f32_16x16x32_bf16 v[104:107], v[164:167], v[148:151], v[104:107]
    ds_read_b64_tr_b16 v[196:197], v76 offset:256
    v_and_b32 v10, 0xffff0000, v8
    v_mfma_f32_16x16x32_bf16 v[112:115], v[164:167], v[152:155], v[112:115]
    ds_read_b64_tr_b16 v[198:199], v76 offset:1024
    v_sub_f32 v212, -v36, v9
    s_waitcnt lgkmcnt(8)
    v_mfma_f32_16x16x32_bf16 v[108:111], v[168:171], v[148:151], v[108:111]
    ds_read_b64_tr_b16 v[200:201], v77 offset:256
    v_sub_f32 v214, v222, v10
    v_mfma_f32_16x16x32_bf16 v[116:119], v[168:171], v[152:155], v[116:119]
    ds_read_b64_tr_b16 v[202:203], v77 offset:1024
    v_cvt_pk_bf16_f32 v212, v9, v212
    v_mfma_f32_16x16x32_bf16 v[120:123], v[172:175], v[148:151], v[120:123]
    ds_read_b64_tr_b16 v[204:205], v76 offset:512
    v_cvt_pk_bf16_f32 v214, v10, v214
    v_mfma_f32_16x16x32_bf16 v[128:131], v[172:175], v[152:155], v[128:131]
    ds_read_b64_tr_b16 v[206:207], v76 offset:1280
    v_mov_b32 v228, v226
    v_mfma_f32_16x16x32_bf16 v[124:127], v[176:179], v[148:151], v[124:127]
    ds_read_b64_tr_b16 v[208:209], v77 offset:512
    v_mov_b32 v224, v222
    v_mfma_f32_16x16x32_bf16 v[132:135], v[176:179], v[152:155], v[132:135]
    ds_read_b64_tr_b16 v[210:211], v77 offset:1280
    s_bitcmp1_b32 s3, 1
    s_cbranch_scc1 M_CS14
    v_mfma_f32_16x16x32_bf16 v[136:139], v[80:83], v[156:159], v[136:139]
    v_mfma_f32_16x16x32_bf16 v[140:143], v[80:83], v[160:163], v[140:143]
    v_mfma_f32_16x16x32_bf16 v[144:147], v[80:83], v[164:167], v[144:147]
    s_branch M_CS15
M_CS14:
    v_mfma_f32_16x16x32_bf16 v[136:139], v[80:83], v[168:171], v[136:139]
    v_mfma_f32_16x16x32_bf16 v[140:143], v[80:83], v[172:175], v[140:143]
    v_mfma_f32_16x16x32_bf16 v[144:147], v[80:83], v[176:179], v[144:147]
M_CS15:
    s_waitcnt lgkmcnt(6)
    v_mfma_f32_16x16x32_bf16 v[88:91], v[188:191], v[180:183], v[88:91]
    v_mov_b32 v220, v64
    v_mov_b32 v216, v212
    v_mfma_f32_16x16x32_bf16 v[96:99], v[188:191], v[184:187], v[96:99]
    v_mov_b32 v218, v214
    s_mov_b32 vcc_lo, 0xffff
    v_mfma_f32_16x16x32_bf16 v[92:95], v[192:195], v[180:183], v[92:95]
    s_mov_b32 vcc_hi, 0
    v_permlane16_swap_b32 v226, v228
    v_mfma_f32_16x16x32_bf16 v[100:103], v[192:195], v[184:187], v[100:103]
    v_permlane16_swap_b32 v222, v224
    v_permlane16_swap_b32 v64, v220
    v_mfma_f32_16x16x32_bf16 v[104:107], v[196:199], v[180:183], v[104:107]
    v_permlane16_swap_b32 v212, v216
    v_permlane16_swap_b32 v214, v218
    v_mfma_f32_16x16x32_bf16 v[112:115], v[196:199], v[184:187], v[112:115]
    v_mov_b32 v213, v212
    v_cndmask_b32 v214, 0, v214, vcc
    v_mov_b32 v217, v216
    v_cndmask_b32 v218, 0, v218, vcc
    s_waitcnt lgkmcnt(0)
    s_barrier
    ds_read_b128 v[148:151], v68 offset:28672
    ds_read_b64_tr_b16 v[156:157], v74 offset:28672
    v_mfma_f32_16x16x32_bf16 v[108:111], v[200:203], v[180:183], v[108:111]
    ds_read_b64_tr_b16 v[158:159], v74 offset:29440
    ds_read_b128 v[152:155], v68 offset:30720
    v_mfma_f32_16x16x32_bf16 v[116:119], v[200:203], v[184:187], v[116:119]
    ds_read_b64_tr_b16 v[160:161], v75 offset:28672
    ds_read_b64_tr_b16 v[162:163], v75 offset:29440
    v_mfma_f32_16x16x32_bf16 v[120:123], v[204:207], v[180:183], v[120:123]
    ds_read_b64_tr_b16 v[164:165], v74 offset:28928
    ds_read_b64_tr_b16 v[166:167], v74 offset:29696
    v_mfma_f32_16x16x32_bf16 v[128:131], v[204:207], v[184:187], v[128:131]
    ds_read_b64_tr_b16 v[168:169], v75 offset:28928
    ds_read_b64_tr_b16 v[170:171], v75 offset:29696
    v_mfma_f32_16x16x32_bf16 v[124:127], v[208:211], v[180:183], v[124:127]
    ds_read_b64_tr_b16 v[172:173], v74 offset:29184
    ds_read_b64_tr_b16 v[174:175], v74 offset:29952
    v_mfma_f32_16x16x32_bf16 v[132:135], v[208:211], v[184:187], v[132:135]
    ds_read_b64_tr_b16 v[176:177], v75 offset:29184
    ds_read_b64_tr_b16 v[178:179], v75 offset:29952
    s_waitcnt lgkmcnt(11)
    v_mfma_f32_16x16x32_bf16 v[88:91], v[156:159], v[148:151], v[88:91]
    ds_read_b128 v[180:183], v69 offset:28672
    s_waitcnt lgkmcnt(11)
    v_mfma_f32_16x16x32_bf16 v[96:99], v[156:159], v[152:155], v[96:99]
    ds_read_b64_tr_b16 v[188:189], v76 offset:28672
    ds_read_b64_tr_b16 v[190:191], v76 offset:29440
    s_waitcnt lgkmcnt(11)
    v_mfma_f32_16x16x32_bf16 v[92:95], v[160:163], v[148:151], v[92:95]
    ds_read_b128 v[184:187], v69 offset:30720
    v_mfma_f32_16x16x32_bf16 v[100:103], v[160:163], v[152:155], v[100:103]
    ds_read_b64_tr_b16 v[192:193], v77 offset:28672
    ds_read_b64_tr_b16 v[194:195], v77 offset:29440
    s_waitcnt lgkmcnt(12)
    v_mfma_f32_16x16x32_bf16 v[104:107], v[164:167], v[148:151], v[104:107]
    ds_read_b64_tr_b16 v[196:197], v76 offset:28928
    v_mfma_f32_16x16x32_bf16 v[112:115], v[164:167], v[152:155], v[112:115]
    ds_read_b64_tr_b16 v[198:199], v76 offset:29696
    s_waitcnt lgkmcnt(8)
    s_bitcmp1_b32 s3, 1
    s_cbranch_scc1 M_CS16
    v_mfma_f32_16x16x32_bf16 v[136:139], v[80:83], v[156:159], v[136:139]
    v_mfma_f32_16x16x32_bf16 v[140:143], v[80:83], v[160:163], v[140:143]
    v_mfma_f32_16x16x32_bf16 v[144:147], v[80:83], v[164:167], v[144:147]
    s_branch M_CS17
M_CS16:
    v_mfma_f32_16x16x32_bf16 v[136:139], v[80:83], v[168:171], v[136:139]
    v_mfma_f32_16x16x32_bf16 v[140:143], v[80:83], v[172:175], v[140:143]
    v_mfma_f32_16x16x32_bf16 v[144:147], v[80:83], v[176:179], v[144:147]
M_CS17:
    v_mfma_f32_16x16x32_bf16 v[108:111], v[168:171], v[148:151], v[108:111]
    ds_read_b64_tr_b16 v[200:201], v77 offset:28928
    v_mfma_f32_16x16x32_bf16 v[116:119], v[168:171], v[152:155], v[116:119]
    ds_read_b64_tr_b16 v[202:203], v77 offset:29696
    v_mfma_f32_16x16x32_bf16 v[120:123], v[172:175], v[148:151], v[120:123]
    ds_read_b64_tr_b16 v[204:205], v76 offset:29184
    v_mfma_f32_16x16x32_bf16 v[128:131], v[172:175], v[152:155], v[128:131]
    ds_read_b64_tr_b16 v[206:207], v76 offset:29952
    v_mfma_f32_16x16x32_bf16 v[124:127], v[176:179], v[148:151], v[124:127]
    ds_read_b64_tr_b16 v[208:209], v77 offset:29184
    v_mfma_f32_16x16x32_bf16 v[132:135], v[176:179], v[152:155], v[132:135]
    ds_read_b64_tr_b16 v[210:211], v77 offset:29952
    ds_write_b32 v84, v136 offset:0
    ds_write_b32 v84, v140 offset:256
    ds_write_b32 v84, v144 offset:512
    s_waitcnt lgkmcnt(9)
    v_mfma_f32_16x16x32_bf16 v[88:91], v[188:191], v[180:183], v[88:91]
    v_mfma_f32_16x16x32_bf16 v[96:99], v[188:191], v[184:187], v[96:99]
    v_mfma_f32_16x16x32_bf16 v[92:95], v[192:195], v[180:183], v[92:95]
    v_mfma_f32_16x16x32_bf16 v[100:103], v[192:195], v[184:187], v[100:103]
    v_mfma_f32_16x16x32_bf16 v[104:107], v[196:199], v[180:183], v[104:107]
    v_mfma_f32_16x16x32_bf16 v[112:115], v[196:199], v[184:187], v[112:115]
    s_waitcnt lgkmcnt(0)
    s_barrier
    ds_read_b32 v41, v87 offset:0
    ds_read_b32 v45, v87 offset:256
    ds_read_b32 v49, v87 offset:512
    ds_read_b32 v53, v87 offset:768
    ds_read_b32 v57, v87 offset:1024
    ds_read_b32 v61, v87 offset:1280
    v_mfma_f32_16x16x32_bf16 v[108:111], v[200:203], v[180:183], v[108:111]
    v_mfma_f32_16x16x32_bf16 v[116:119], v[200:203], v[184:187], v[116:119]
    v_mfma_f32_16x16x32_bf16 v[120:123], v[204:207], v[180:183], v[120:123]
    v_mfma_f32_16x16x32_bf16 v[128:131], v[204:207], v[184:187], v[128:131]
    v_mfma_f32_16x16x32_bf16 v[124:127], v[208:211], v[180:183], v[124:127]
    v_mfma_f32_16x16x32_bf16 v[132:135], v[208:211], v[184:187], v[132:135]
M_G1E:
    s_waitcnt lgkmcnt(5)
    v_cvt_pk_bf16_f32 v40, v41, v41
    v_and_b32 v8, 0xffff0000, v40
    v_sub_f32 v41, v41, v8
    v_cvt_pk_bf16_f32 v41, v41, v41
    s_waitcnt lgkmcnt(4)
    v_cvt_pk_bf16_f32 v44, v45, v45
    v_and_b32 v8, 0xffff0000, v44
    v_sub_f32 v45, v45, v8
    v_cvt_pk_bf16_f32 v45, v45, v45
    v_mfma_f32_16x16x32_bf16 v[88:91], v[40:43], v[212:215], v[88:91]
    s_nop 0
    v_mfma_f32_16x16x32_bf16 v[92:95], v[44:47], v[212:215], v[92:95]
    v_mfma_f32_16x16x32_bf16 v[96:99], v[40:43], v[216:219], v[96:99]
    v_mfma_f32_16x16x32_bf16 v[100:103], v[44:47], v[216:219], v[100:103]
    s_waitcnt lgkmcnt(3)
    v_cvt_pk_bf16_f32 v48, v49, v49
    v_and_b32 v8, 0xffff0000, v48
    v_sub_f32 v49, v49, v8
    v_cvt_pk_bf16_f32 v49, v49, v49
    s_waitcnt lgkmcnt(2)
    v_cvt_pk_bf16_f32 v52, v53, v53
    v_and_b32 v8, 0xffff0000, v52
    v_sub_f32 v53, v53, v8
    v_cvt_pk_bf16_f32 v53, v53, v53
    s_waitcnt lgkmcnt(1)
    v_cvt_pk_bf16_f32 v56, v57, v57
    v_and_b32 v8, 0xffff0000, v56
    v_sub_f32 v57, v57, v8
    v_cvt_pk_bf16_f32 v57, v57, v57
    s_waitcnt lgkmcnt(0)
    v_cvt_pk_bf16_f32 v60, v61, v61
    v_and_b32 v8, 0xffff0000, v60
    v_sub_f32 v61, v61, v8
    v_cvt_pk_bf16_f32 v61, v61, v61
    v_pk_mul_f32 v[32:33], v[88:89], v[88:89]
    v_pk_mul_f32 v[34:35], v[90:91], v[90:91]
    v_pk_mul_f32 v[36:37], v[92:93], v[92:93]
    v_pk_mul_f32 v[38:39], v[94:95], v[94:95]
    v_pk_fma_f32 v[32:33], v[32:33], v[64:65], v[226:227] op_sel_hi:[1,0,0]
    v_pk_fma_f32 v[34:35], v[34:35], v[64:65], v[226:227] op_sel_hi:[1,0,0]
    v_pk_fma_f32 v[36:37], v[36:37], v[64:65], v[226:227] op_sel_hi:[1,0,0]
    v_pk_fma_f32 v[38:39], v[38:39], v[64:65], v[226:227] op_sel_hi:[1,0,0]
    v_pk_mul_f32 v[32:33], v[32:33], v[88:89]
    v_pk_mul_f32 v[34:35], v[34:35], v[90:91]
    v_pk_mul_f32 v[36:37], v[36:37], v[92:93]
    v_pk_mul_f32 v[38:39], v[38:39], v[94:95]
    v_mfma_f32_16x16x32_bf16 v[104:107], v[48:51], v[212:215], v[104:107]
    v_exp_f32 v32, v32
    v_exp_f32 v33, v33
    v_mfma_f32_16x16x32_bf16 v[112:115], v[48:51], v[216:219], v[112:115]
    v_exp_f32 v34, v34
    v_exp_f32 v35, v35
    v_mfma_f32_16x16x32_bf16 v[108:111], v[52:55], v[212:215], v[108:111]
    v_exp_f32 v36, v36
    v_exp_f32 v37, v37
    v_exp_f32 v38, v38
    v_exp_f32 v39, v39
    v_pk_fma_f32 v[32:33], v[32:33], v[222:223], v[222:223] op_sel_hi:[1,0,0]
    v_pk_fma_f32 v[34:35], v[34:35], v[222:223], v[222:223] op_sel_hi:[1,0,0]
    v_pk_fma_f32 v[36:37], v[36:37], v[222:223], v[222:223] op_sel_hi:[1,0,0]
    v_pk_fma_f32 v[38:39], v[38:39], v[222:223], v[222:223] op_sel_hi:[1,0,0]
    v_mfma_f32_16x16x32_bf16 v[116:119], v[52:55], v[216:219], v[116:119]
    v_rcp_f32 v32, v32
    v_rcp_f32 v33, v33
    v_mfma_f32_16x16x32_bf16 v[120:123], v[56:59], v[212:215], v[120:123]
    v_rcp_f32 v34, v34
    v_rcp_f32 v35, v35
    v_mfma_f32_16x16x32_bf16 v[128:131], v[56:59], v[216:219], v[128:131]
    v_rcp_f32 v36, v36
    v_rcp_f32 v37, v37
    v_rcp_f32 v38, v38
    v_rcp_f32 v39, v39
    v_pk_mul_f32 v[32:33], v[32:33], v[88:89]
    v_pk_mul_f32 v[34:35], v[34:35], v[90:91]
    v_pk_mul_f32 v[36:37], v[36:37], v[92:93]
    v_pk_mul_f32 v[38:39], v[38:39], v[94:95]
    v_cvt_pk_bf16_f32 v68, v32, v33
    v_cvt_pk_bf16_f32 v69, v34, v35
    v_cvt_pk_bf16_f32 v70, v36, v37
    v_cvt_pk_bf16_f32 v71, v38, v39
    buffer_store_dwordx4 v[68:71], v30, s[20:23], s66 offen offset:0 sc1
    v_pk_mul_f32 v[32:33], v[96:97], v[96:97]
    v_pk_mul_f32 v[34:35], v[98:99], v[98:99]
    v_pk_mul_f32 v[36:37], v[100:101], v[100:101]
    v_pk_mul_f32 v[38:39], v[102:103], v[102:103]
    v_pk_fma_f32 v[32:33], v[32:33], v[220:221], v[228:229] op_sel_hi:[1,0,0]
    v_pk_fma_f32 v[34:35], v[34:35], v[220:221], v[228:229] op_sel_hi:[1,0,0]
    v_pk_fma_f32 v[36:37], v[36:37], v[220:221], v[228:229] op_sel_hi:[1,0,0]
    v_pk_fma_f32 v[38:39], v[38:39], v[220:221], v[228:229] op_sel_hi:[1,0,0]
    v_pk_mul_f32 v[32:33], v[32:33], v[96:97]
    v_pk_mul_f32 v[34:35], v[34:35], v[98:99]
    v_pk_mul_f32 v[36:37], v[36:37], v[100:101]
    v_pk_mul_f32 v[38:39], v[38:39], v[102:103]
    v_mfma_f32_16x16x32_bf16 v[124:127], v[60:63], v[212:215], v[124:127]
    v_exp_f32 v32, v32
    v_exp_f32 v33, v33
    v_mfma_f32_16x16x32_bf16 v[132:135], v[60:63], v[216:219], v[132:135]
    v_exp_f32 v34, v34
    v_exp_f32 v35, v35
    v_exp_f32 v36, v36
    v_exp_f32 v37, v37
    v_exp_f32 v38, v38
    v_exp_f32 v39, v39
    v_pk_fma_f32 v[32:33], v[32:33], v[224:225], v[224:225] op_sel_hi:[1,0,0]
    v_pk_fma_f32 v[34:35], v[34:35], v[224:225], v[224:225] op_sel_hi:[1,0,0]
    v_pk_fma_f32 v[36:37], v[36:37], v[224:225], v[224:225] op_sel_hi:[1,0,0]
    v_pk_fma_f32 v[38:39], v[38:39], v[224:225], v[224:225] op_sel_hi:[1,0,0]
    v_rcp_f32 v32, v32
    v_rcp_f32 v33, v33
    v_rcp_f32 v34, v34
    v_rcp_f32 v35, v35
    v_rcp_f32 v36, v36
    v_rcp_f32 v37, v37
    v_rcp_f32 v38, v38
    v_rcp_f32 v39, v39
    v_pk_mul_f32 v[32:33], v[32:33], v[96:97]
    v_pk_mul_f32 v[34:35], v[34:35], v[98:99]
    v_pk_mul_f32 v[36:37], v[36:37], v[100:101]
    v_pk_mul_f32 v[38:39], v[38:39], v[102:103]
    v_cvt_pk_bf16_f32 v72, v32, v33
    v_cvt_pk_bf16_f32 v73, v34, v35
    v_cvt_pk_bf16_f32 v74, v36, v37
    v_cvt_pk_bf16_f32 v75, v38, v39
    buffer_store_dwordx4 v[72:75], v30, s[20:23], s66 offen offset:256 sc1
    v_pk_mul_f32 v[32:33], v[104:105], v[104:105]
    v_pk_mul_f32 v[34:35], v[106:107], v[106:107]
    v_pk_mul_f32 v[36:37], v[108:109], v[108:109]
    v_pk_mul_f32 v[38:39], v[110:111], v[110:111]
    v_pk_fma_f32 v[32:33], v[32:33], v[64:65], v[226:227] op_sel_hi:[1,0,0]
    v_pk_fma_f32 v[34:35], v[34:35], v[64:65], v[226:227] op_sel_hi:[1,0,0]
    v_pk_fma_f32 v[36:37], v[36:37], v[64:65], v[226:227] op_sel_hi:[1,0,0]
    v_pk_fma_f32 v[38:39], v[38:39], v[64:65], v[226:227] op_sel_hi:[1,0,0]
    v_pk_mul_f32 v[32:33], v[32:33], v[104:105]
    v_pk_mul_f32 v[34:35], v[34:35], v[106:107]
    v_pk_mul_f32 v[36:37], v[36:37], v[108:109]
    v_pk_mul_f32 v[38:39], v[38:39], v[110:111]
    v_exp_f32 v32, v32
    v_exp_f32 v33, v33
    v_exp_f32 v34, v34
    v_exp_f32 v35, v35
    v_exp_f32 v36, v36
    v_exp_f32 v37, v37
    v_exp_f32 v38, v38
    v_exp_f32 v39, v39
    v_pk_fma_f32 v[32:33], v[32:33], v[222:223], v[222:223] op_sel_hi:[1,0,0]
    v_pk_fma_f32 v[34:35], v[34:35], v[222:223], v[222:223] op_sel_hi:[1,0,0]
    v_pk_fma_f32 v[36:37], v[36:37], v[222:223], v[222:223] op_sel_hi:[1,0,0]
    v_pk_fma_f32 v[38:39], v[38:39], v[222:223], v[222:223] op_sel_hi:[1,0,0]
    v_rcp_f32 v32, v32
    v_rcp_f32 v33, v33
    v_rcp_f32 v34, v34
    v_rcp_f32 v35, v35
    v_rcp_f32 v36, v36
    v_rcp_f32 v37, v37
    v_rcp_f32 v38, v38
    v_rcp_f32 v39, v39
    v_pk_mul_f32 v[32:33], v[32:33], v[104:105]
    v_pk_mul_f32 v[34:35], v[34:35], v[106:107]
    v_pk_mul_f32 v[36:37], v[36:37], v[108:109]
    v_pk_mul_f32 v[38:39], v[38:39], v[110:111]
    v_cvt_pk_bf16_f32 v68, v32, v33
    v_cvt_pk_bf16_f32 v69, v34, v35
    v_cvt_pk_bf16_f32 v70, v36, v37
    v_cvt_pk_bf16_f32 v71, v38, v39
    buffer_store_dwordx4 v[68:71], v30, s[20:23], s66 offen offset:2048 sc1
    v_pk_mul_f32 v[32:33], v[112:113], v[112:113]
    v_pk_mul_f32 v[34:35], v[114:115], v[114:115]
    v_pk_mul_f32 v[36:37], v[116:117], v[116:117]
    v_pk_mul_f32 v[38:39], v[118:119], v[118:119]
    v_pk_fma_f32 v[32:33], v[32:33], v[220:221], v[228:229] op_sel_hi:[1,0,0]
    v_pk_fma_f32 v[34:35], v[34:35], v[220:221], v[228:229] op_sel_hi:[1,0,0]
    v_pk_fma_f32 v[36:37], v[36:37], v[220:221], v[228:229] op_sel_hi:[1,0,0]
    v_pk_fma_f32 v[38:39], v[38:39], v[220:221], v[228:229] op_sel_hi:[1,0,0]
    v_pk_mul_f32 v[32:33], v[32:33], v[112:113]
    v_pk_mul_f32 v[34:35], v[34:35], v[114:115]
    v_pk_mul_f32 v[36:37], v[36:37], v[116:117]
    v_pk_mul_f32 v[38:39], v[38:39], v[118:119]
    v_exp_f32 v32, v32
    v_exp_f32 v33, v33
    v_exp_f32 v34, v34
    v_exp_f32 v35, v35
    v_exp_f32 v36, v36
    v_exp_f32 v37, v37
    v_exp_f32 v38, v38
    v_exp_f32 v39, v39
    v_pk_fma_f32 v[32:33], v[32:33], v[224:225], v[224:225] op_sel_hi:[1,0,0]
    v_pk_fma_f32 v[34:35], v[34:35], v[224:225], v[224:225] op_sel_hi:[1,0,0]
    v_pk_fma_f32 v[36:37], v[36:37], v[224:225], v[224:225] op_sel_hi:[1,0,0]
    v_pk_fma_f32 v[38:39], v[38:39], v[224:225], v[224:225] op_sel_hi:[1,0,0]
    v_rcp_f32 v32, v32
    v_rcp_f32 v33, v33
    v_rcp_f32 v34, v34
    v_rcp_f32 v35, v35
    v_rcp_f32 v36, v36
    v_rcp_f32 v37, v37
    v_rcp_f32 v38, v38
    v_rcp_f32 v39, v39
    v_pk_mul_f32 v[32:33], v[32:33], v[112:113]
    v_pk_mul_f32 v[34:35], v[34:35], v[114:115]
    v_pk_mul_f32 v[36:37], v[36:37], v[116:117]
    v_pk_mul_f32 v[38:39], v[38:39], v[118:119]
    v_cvt_pk_bf16_f32 v72, v32, v33
    v_cvt_pk_bf16_f32 v73, v34, v35
    v_cvt_pk_bf16_f32 v74, v36, v37
    v_cvt_pk_bf16_f32 v75, v38, v39
    buffer_store_dwordx4 v[72:75], v30, s[20:23], s66 offen offset:2304 sc1
    s_barrier
    s_bitcmp1_b32 0xc888, s53
    s_cbranch_scc1 M_LIGHT
    s_add_u32 s66, s66, 4096
    v_pk_mul_f32 v[32:33], v[120:121], v[120:121]
    v_pk_mul_f32 v[34:35], v[122:123], v[122:123]
    v_pk_mul_f32 v[36:37], v[124:125], v[124:125]
    v_pk_mul_f32 v[38:39], v[126:127], v[126:127]
    v_pk_fma_f32 v[32:33], v[32:33], v[64:65], v[226:227] op_sel_hi:[1,0,0]
    v_pk_fma_f32 v[34:35], v[34:35], v[64:65], v[226:227] op_sel_hi:[1,0,0]
    v_pk_fma_f32 v[36:37], v[36:37], v[64:65], v[226:227] op_sel_hi:[1,0,0]
    v_pk_fma_f32 v[38:39], v[38:39], v[64:65], v[226:227] op_sel_hi:[1,0,0]
    v_pk_mul_f32 v[32:33], v[32:33], v[120:121]
    v_pk_mul_f32 v[34:35], v[34:35], v[122:123]
    v_pk_mul_f32 v[36:37], v[36:37], v[124:125]
    v_pk_mul_f32 v[38:39], v[38:39], v[126:127]
    v_exp_f32 v32, v32
    v_exp_f32 v33, v33
    v_exp_f32 v34, v34
    v_exp_f32 v35, v35
    v_exp_f32 v36, v36
    v_exp_f32 v37, v37
    v_exp_f32 v38, v38
    v_exp_f32 v39, v39
    v_pk_fma_f32 v[32:33], v[32:33], v[222:223], v[222:223] op_sel_hi:[1,0,0]
    v_pk_fma_f32 v[34:35], v[34:35], v[222:223], v[222:223] op_sel_hi:[1,0,0]
    v_pk_fma_f32 v[36:37], v[36:37], v[222:223], v[222:223] op_sel_hi:[1,0,0]
    v_pk_fma_f32 v[38:39], v[38:39], v[222:223], v[222:223] op_sel_hi:[1,0,0]
    v_rcp_f32 v32, v32
    v_rcp_f32 v33, v33
    v_rcp_f32 v34, v34
    v_rcp_f32 v35, v35
    v_rcp_f32 v36, v36
    v_rcp_f32 v37, v37
    v_rcp_f32 v38, v38
    v_rcp_f32 v39, v39
    v_pk_mul_f32 v[32:33], v[32:33], v[120:121]
    v_pk_mul_f32 v[34:35], v[34:35], v[122:123]
    v_pk_mul_f32 v[36:37], v[36:37], v[124:125]
    v_pk_mul_f32 v[38:39], v[38:39], v[126:127]
    v_cvt_pk_bf16_f32 v68, v32, v33
    v_cvt_pk_bf16_f32 v69, v34, v35
    v_cvt_pk_bf16_f32 v70, v36, v37
    v_cvt_pk_bf16_f32 v71, v38, v39
    buffer_store_dwordx4 v[68:71], v30, s[20:23], s66 offen offset:0 sc1
    s_waitcnt vmcnt(3)
    s_mov_b64 exec, 0xff
    buffer_store_dwordx4 v[12:15], v3, s[20:23], s76 offen offset:0 sc1
    s_mov_b64 exec, -1
    v_pk_mul_f32 v[32:33], v[128:129], v[128:129]
    v_pk_mul_f32 v[34:35], v[130:131], v[130:131]
    v_pk_mul_f32 v[36:37], v[132:133], v[132:133]
    v_pk_mul_f32 v[38:39], v[134:135], v[134:135]
    v_pk_fma_f32 v[32:33], v[32:33], v[220:221], v[228:229] op_sel_hi:[1,0,0]
    v_pk_fma_f32 v[34:35], v[34:35], v[220:221], v[228:229] op_sel_hi:[1,0,0]
    v_pk_fma_f32 v[36:37], v[36:37], v[220:221], v[228:229] op_sel_hi:[1,0,0]
    v_pk_fma_f32 v[38:39], v[38:39], v[220:221], v[228:229] op_sel_hi:[1,0,0]
    v_pk_mul_f32 v[32:33], v[32:33], v[128:129]
    v_pk_mul_f32 v[34:35], v[34:35], v[130:131]
    v_pk_mul_f32 v[36:37], v[36:37], v[132:133]
    v_pk_mul_f32 v[38:39], v[38:39], v[134:135]
    v_exp_f32 v32, v32
    v_exp_f32 v33, v33
    v_exp_f32 v34, v34
    v_exp_f32 v35, v35
    v_exp_f32 v36, v36
    v_exp_f32 v37, v37
    v_exp_f32 v38, v38
    v_exp_f32 v39, v39
    v_pk_fma_f32 v[32:33], v[32:33], v[224:225], v[224:225] op_sel_hi:[1,0,0]
    v_pk_fma_f32 v[34:35], v[34:35], v[224:225], v[224:225] op_sel_hi:[1,0,0]
    v_pk_fma_f32 v[36:37], v[36:37], v[224:225], v[224:225] op_sel_hi:[1,0,0]
    v_pk_fma_f32 v[38:39], v[38:39], v[224:225], v[224:225] op_sel_hi:[1,0,0]
    v_rcp_f32 v32, v32
    v_rcp_f32 v33, v33
    v_rcp_f32 v34, v34
    v_rcp_f32 v35, v35
    v_rcp_f32 v36, v36
    v_rcp_f32 v37, v37
    v_rcp_f32 v38, v38
    v_rcp_f32 v39, v39
    v_pk_mul_f32 v[32:33], v[32:33], v[128:129]
    v_pk_mul_f32 v[34:35], v[34:35], v[130:131]
    v_pk_mul_f32 v[36:37], v[36:37], v[132:133]
    v_pk_mul_f32 v[38:39], v[38:39], v[134:135]
    v_cvt_pk_bf16_f32 v72, v32, v33
    v_cvt_pk_bf16_f32 v73, v34, v35
    v_cvt_pk_bf16_f32 v74, v36, v37
    v_cvt_pk_bf16_f32 v75, v38, v39
    buffer_store_dwordx4 v[72:75], v30, s[20:23], s66 offen offset:256 sc1
    s_barrier
    s_branch M_SKIP2
M_LIGHT:
    s_barrier
    s_waitcnt vmcnt(2)
    s_mov_b64 exec, 0xff
    buffer_store_dwordx4 v[12:15], v3, s[20:23], s76 offen offset:0 sc1
    s_mov_b64 exec, -1
M_SKIP2:
    s_add_u32 m0, s81, 57344
    s_add_u32 s55, s27, 8192
    buffer_load_dwordx4 v5, s[16:19], s55 offen lds
    buffer_load_dwordx4 v6, s[16:19], s55 offen offset:1024 lds
    ds_read_b64_tr_b16 v[32:33], v24 offset:0
    ds_read_b64_tr_b16 v[34:35], v24 offset:1024
    ds_read_b64_tr_b16 v[36:37], v24 offset:256
    ds_read_b64_tr_b16 v[38:39], v24 offset:1280
    s_add_u32 m0, s81, 65536
    s_add_u32 s55, s24, 32768
    buffer_load_dwordx4 v5, s[16:19], s55 offen lds
    buffer_load_dwordx4 v6, s[16:19], s55 offen offset:1024 lds
    ds_read_b64_tr_b16 v[40:41], v24 offset:8192
    ds_read_b64_tr_b16 v[42:43], v24 offset:9216
    ds_read_b64_tr_b16 v[44:45], v24 offset:8448
    ds_read_b64_tr_b16 v[46:47], v24 offset:9472
    s_add_u32 m0, s81, 73728
    s_add_u32 s55, s24, 40960
    buffer_load_dwordx4 v5, s[16:19], s55 offen lds
    buffer_load_dwordx4 v6, s[16:19], s55 offen offset:1024 lds
    ds_read_b64_tr_b16 v[48:49], v24 offset:16384
    ds_read_b64_tr_b16 v[50:51], v24 offset:17408
    ds_read_b64_tr_b16 v[52:53], v24 offset:16640
    ds_read_b64_tr_b16 v[54:55], v24 offset:17664
    s_waitcnt vmcnt(6)
    s_mov_b64 exec, 0xff
    buffer_store_dwordx4 v[12:15], v3, s[20:23], s76 offen offset:128 sc1
    s_mov_b64 exec, -1
    s_add_u32 m0, s81, 81920
    s_add_u32 s55, s25, 32768
    buffer_load_dwordx4 v5, s[16:19], s55 offen lds
    buffer_load_dwordx4 v6, s[16:19], s55 offen offset:1024 lds
    s_waitcnt vmcnt(8)
    s_add_u32 m0, s81, 90112
    s_add_u32 s55, s25, 40960
    buffer_load_dwordx4 v5, s[16:19], s55 offen lds
    buffer_load_dwordx4 v6, s[16:19], s55 offen offset:1024 lds
    s_waitcnt vmcnt(8)
    s_add_u32 m0, s81, 98304
    s_add_u32 s55, s26, 32768
    buffer_load_dwordx4 v5, s[16:19], s55 offen lds
    buffer_load_dwordx4 v6, s[16:19], s55 offen offset:1024 lds
    s_mov_b64 exec, 0xff
    buffer_load_dword v27, v29, s[20:23], s73 offen offset:0 sc1
    s_mov_b64 exec, -1
    s_waitcnt vmcnt(8)
    s_add_u32 m0, s81, 106496
    s_add_u32 s55, s26, 40960
    buffer_load_dwordx4 v5, s[16:19], s55 offen lds
    buffer_load_dwordx4 v6, s[16:19], s55 offen offset:1024 lds
    s_waitcnt vmcnt(8)
    s_waitcnt lgkmcnt(8)
    s_add_u32 m0, s81, 0
    s_add_u32 s55, s27, 32768
    buffer_load_dwordx4 v5, s[16:19], s55 offen lds
    buffer_load_dwordx4 v6, s[16:19], s55 offen offset:1024 lds
    s_waitcnt vmcnt(8)
    s_waitcnt lgkmcnt(4)
    s_add_u32 m0, s81, 8192
    s_add_u32 s55, s27, 40960
    buffer_load_dwordx4 v5, s[16:19], s55 offen lds
    buffer_load_dwordx4 v6, s[16:19], s55 offen offset:1024 lds
    s_waitcnt vmcnt(8)
    s_waitcnt lgkmcnt(0)
    s_add_u32 m0, s81, 16384
    s_add_u32 s55, s67, 65536
    buffer_load_dwordx4 v5, s[16:19], s55 offen lds
    buffer_load_dwordx4 v6, s[16:19], s55 offen offset:1024 lds
    s_mov_b32 s65, 0
    s_mov_b64 exec, 0xff
    s_waitcnt vmcnt(8)
    v_cmp_ne_u32 vcc, v27, v4
    s_cbranch_vccnz M_HRETRY0
M_HOK0:
    s_mov_b64 exec, -1
    s_add_u32 s60, s40, 0
    buffer_load_dwordx4 v[160:163], v3, s[20:23], s60 offen offset:0 sc1
    buffer_load_dwordx4 v[164:167], v26, s[20:23], s60 offen offset:0 sc1
    buffer_load_dwordx4 v[168:171], v3, s[20:23], s60 offen offset:1024 sc1
    buffer_load_dwordx4 v[172:175], v26, s[20:23], s60 offen offset:1024 sc1
    s_waitcnt vmcnt(11)
    s_add_u32 s60, s41, 0
    buffer_load_dwordx4 v[176:179], v3, s[20:23], s60 offen offset:0 sc1
    s_waitcnt vmcnt(11)
    buffer_load_dwordx4 v[180:183], v26, s[20:23], s60 offen offset:0 sc1
    s_waitcnt vmcnt(11)
    buffer_load_dwordx4 v[184:187], v3, s[20:23], s60 offen offset:1024 sc1
    s_waitcnt vmcnt(11)
    buffer_load_dwordx4 v[188:191], v26, s[20:23], s60 offen offset:1024 sc1
    s_waitcnt vmcnt(11)
    s_add_u32 s60, s42, 0
    buffer_load_dwordx4 v[192:195], v3, s[20:23], s60 offen offset:0 sc1
    s_waitcnt vmcnt(11)
    buffer_load_dwordx4 v[196:199], v26, s[20:23], s60 offen offset:0 sc1
    s_mov_b64 exec, 0xff
    buffer_load_dword v28, v29, s[20:23], s73 offen offset:128 sc1
    s_mov_b64 exec, -1
    s_waitcnt vmcnt(11)
    buffer_load_dwordx4 v[200:203], v3, s[20:23], s60 offen offset:1024 sc1
    s_waitcnt vmcnt(11)
    buffer_load_dwordx4 v[204:207], v26, s[20:23], s60 offen offset:1024 sc1
    s_waitcnt vmcnt(11)
    s_add_u32 s60, s43, 0
    buffer_load_dwordx4 v[208:211], v3, s[20:23], s60 offen offset:0 sc1
    s_waitcnt vmcnt(11)
    buffer_load_dwordx4 v[212:215], v26, s[20:23], s60 offen offset:0 sc1
    s_barrier
    v_mfma_f32_32x32x16_bf16 v[96:111], v[32:35], v[160:163], 0
    v_mfma_f32_32x32x16_bf16 v[112:127], v[36:39], v[160:163], 0
    buffer_load_dwordx4 v[160:163], v3, s[20:23], s60 offen offset:1024 sc1
    v_mfma_f32_32x32x16_bf16 v[128:143], v[32:35], v[164:167], 0
    v_mfma_f32_32x32x16_bf16 v[144:159], v[36:39], v[164:167], 0
    buffer_load_dwordx4 v[164:167], v26, s[20:23], s60 offen offset:1024 sc1
    v_mfma_f32_32x32x16_bf16 v[96:111], v[40:43], v[168:171], v[96:111]
    v_mfma_f32_32x32x16_bf16 v[112:127], v[44:47], v[168:171], v[112:127]
    s_mov_b64 exec, 0xff
    s_waitcnt vmcnt(6)
    v_cmp_ne_u32 vcc, v28, v4
    s_cbranch_vccnz M_HRETRY1
M_HOK1:
    s_mov_b64 exec, -1
    s_add_u32 s60, s40, 2048
    buffer_load_dwordx4 v[168:171], v3, s[20:23], s60 offen offset:0 sc1
    v_mfma_f32_32x32x16_bf16 v[128:143], v[40:43], v[172:175], v[128:143]
    v_mfma_f32_32x32x16_bf16 v[144:159], v[44:47], v[172:175], v[144:159]
    buffer_load_dwordx4 v[172:175], v26, s[20:23], s60 offen offset:0 sc1
    v_mfma_f32_32x32x16_bf16 v[96:111], v[48:51], v[176:179], v[96:111]
    ds_read_b64_tr_b16 v[224:225], v24 offset:24576
    ds_read_b64_tr_b16 v[226:227], v24 offset:25600
    ds_read_b64_tr_b16 v[228:229], v24 offset:24832
    ds_read_b64_tr_b16 v[230:231], v24 offset:25856
    v_mfma_f32_32x32x16_bf16 v[112:127], v[52:55], v[176:179], v[112:127]
    buffer_load_dwordx4 v[176:179], v3, s[20:23], s60 offen offset:1024 sc1
    v_mfma_f32_32x32x16_bf16 v[128:143], v[48:51], v[180:183], v[128:143]
    v_mfma_f32_32x32x16_bf16 v[144:159], v[52:55], v[180:183], v[144:159]
    buffer_load_dwordx4 v[180:183], v26, s[20:23], s60 offen offset:1024 sc1
    s_waitcnt lgkmcnt(2)
    v_mfma_f32_32x32x16_bf16 v[96:111], v[224:227], v[184:187], v[96:111]
    ds_read_b64_tr_b16 v[216:217], v24 offset:32768
    ds_read_b64_tr_b16 v[218:219], v24 offset:33792
    ds_read_b64_tr_b16 v[220:221], v24 offset:33024
    ds_read_b64_tr_b16 v[222:223], v24 offset:34048
    s_waitcnt lgkmcnt(4)
    v_mfma_f32_32x32x16_bf16 v[112:127], v[228:231], v[184:187], v[112:127]
    s_add_u32 s60, s41, 2048
    buffer_load_dwordx4 v[184:187], v3, s[20:23], s60 offen offset:0 sc1
    v_mfma_f32_32x32x16_bf16 v[128:143], v[224:227], v[188:191], v[128:143]
    v_mfma_f32_32x32x16_bf16 v[144:159], v[228:231], v[188:191], v[144:159]
    buffer_load_dwordx4 v[188:191], v26, s[20:23], s60 offen offset:0 sc1
    s_waitcnt lgkmcnt(2)
    v_mfma_f32_32x32x16_bf16 v[96:111], v[216:219], v[192:195], v[96:111]
    ds_read_b64_tr_b16 v[224:225], v24 offset:40960
    ds_read_b64_tr_b16 v[226:227], v24 offset:41984
    ds_read_b64_tr_b16 v[228:229], v24 offset:41216
    ds_read_b64_tr_b16 v[230:231], v24 offset:42240
    s_waitcnt lgkmcnt(4)
    v_mfma_f32_32x32x16_bf16 v[112:127], v[220:223], v[192:195], v[112:127]
    buffer_load_dwordx4 v[192:195], v3, s[20:23], s60 offen offset:1024 sc1
    v_mfma_f32_32x32x16_bf16 v[128:143], v[216:219], v[196:199], v[128:143]
    v_mfma_f32_32x32x16_bf16 v[144:159], v[220:223], v[196:199], v[144:159]
    buffer_load_dwordx4 v[196:199], v26, s[20:23], s60 offen offset:1024 sc1
    s_waitcnt vmcnt(13) lgkmcnt(2)
    v_mfma_f32_32x32x16_bf16 v[96:111], v[224:227], v[200:203], v[96:111]
    ds_read_b64_tr_b16 v[216:217], v24 offset:49152
    ds_read_b64_tr_b16 v[218:219], v24 offset:50176
    ds_read_b64_tr_b16 v[220:221], v24 offset:49408
    ds_read_b64_tr_b16 v[222:223], v24 offset:50432
    s_waitcnt lgkmcnt(4)
    v_mfma_f32_32x32x16_bf16 v[112:127], v[228:231], v[200:203], v[112:127]
    s_add_u32 s60, s42, 2048
    buffer_load_dwordx4 v[200:203], v3, s[20:23], s60 offen offset:0 sc1
    s_waitcnt vmcnt(13)
    v_mfma_f32_32x32x16_bf16 v[128:143], v[224:227], v[204:207], v[128:143]
    v_mfma_f32_32x32x16_bf16 v[144:159], v[228:231], v[204:207], v[144:159]
    buffer_load_dwordx4 v[204:207], v26, s[20:23], s60 offen offset:0 sc1
    s_waitcnt vmcnt(13) lgkmcnt(2)
    v_mfma_f32_32x32x16_bf16 v[96:111], v[216:219], v[208:211], v[96:111]
    ds_read_b64_tr_b16 v[224:225], v24 offset:57344
    ds_read_b64_tr_b16 v[226:227], v24 offset:58368
    ds_read_b64_tr_b16 v[228:229], v24 offset:57600
    ds_read_b64_tr_b16 v[230:231], v24 offset:58624
    s_waitcnt lgkmcnt(4)
    v_mfma_f32_32x32x16_bf16 v[112:127], v[220:223], v[208:211], v[112:127]
    s_waitcnt vmcnt(12)
    v_mfma_f32_32x32x16_bf16 v[128:143], v[216:219], v[212:215], v[128:143]
    v_mfma_f32_32x32x16_bf16 v[144:159], v[220:223], v[212:215], v[144:159]
    buffer_load_dwordx4 v[208:211], v3, s[20:23], s60 offen offset:1024 sc1
    s_waitcnt vmcnt(12) lgkmcnt(2)
    v_mfma_f32_32x32x16_bf16 v[96:111], v[224:227], v[160:163], v[96:111]
    ds_read_b64_tr_b16 v[216:217], v25 offset:0
    ds_read_b64_tr_b16 v[218:219], v25 offset:1024
    ds_read_b64_tr_b16 v[220:221], v25 offset:256
    ds_read_b64_tr_b16 v[222:223], v25 offset:1280
    s_waitcnt lgkmcnt(4)
    v_mfma_f32_32x32x16_bf16 v[112:127], v[228:231], v[160:163], v[112:127]
    buffer_load_dwordx4 v[212:215], v26, s[20:23], s60 offen offset:1024 sc1
    s_waitcnt vmcnt(12)
    v_mfma_f32_32x32x16_bf16 v[128:143], v[224:227], v[164:167], v[128:143]
    v_mfma_f32_32x32x16_bf16 v[144:159], v[228:231], v[164:167], v[144:159]
    s_add_u32 s60, s43, 2048
    buffer_load_dwordx4 v[160:163], v3, s[20:23], s60 offen offset:0 sc1
    s_waitcnt vmcnt(12) lgkmcnt(2)
    v_mfma_f32_32x32x16_bf16 v[96:111], v[216:219], v[168:171], v[96:111]
    ds_read_b64_tr_b16 v[224:225], v25 offset:8192
    ds_read_b64_tr_b16 v[226:227], v25 offset:9216
    ds_read_b64_tr_b16 v[228:229], v25 offset:8448
    ds_read_b64_tr_b16 v[230:231], v25 offset:9472
    s_waitcnt lgkmcnt(4)
    v_mfma_f32_32x32x16_bf16 v[112:127], v[220:223], v[168:171], v[112:127]
    s_add_u32 m0, s81, 24576
    s_add_u32 s55, s67, 73728
    buffer_load_dwordx4 v5, s[16:19], s55 offen lds
    s_waitcnt vmcnt(12)
    v_mfma_f32_32x32x16_bf16 v[128:143], v[216:219], v[172:175], v[128:143]
    v_mfma_f32_32x32x16_bf16 v[144:159], v[220:223], v[172:175], v[144:159]
    buffer_load_dwordx4 v6, s[16:19], s55 offen offset:1024 lds
    s_waitcnt vmcnt(12) lgkmcnt(2)
    v_mfma_f32_32x32x16_bf16 v[96:111], v[224:227], v[176:179], v[96:111]
    ds_read_b64_tr_b16 v[216:217], v25 offset:16384
    ds_read_b64_tr_b16 v[218:219], v25 offset:17408
    ds_read_b64_tr_b16 v[220:221], v25 offset:16640
    ds_read_b64_tr_b16 v[222:223], v25 offset:17664
    s_waitcnt lgkmcnt(4)
    v_mfma_f32_32x32x16_bf16 v[112:127], v[228:231], v[176:179], v[112:127]
    buffer_load_dwordx4 v[164:167], v3, s[20:23], s60 offen offset:1024 sc1
    s_waitcnt vmcnt(12)
    v_mfma_f32_32x32x16_bf16 v[128:143], v[224:227], v[180:183], v[128:143]
    v_mfma_f32_32x32x16_bf16 v[144:159], v[228:231], v[180:183], v[144:159]
    s_add_u32 m0, s81, 32768
    s_add_u32 s55, s67, 163840
    buffer_load_dwordx4 v5, s[16:19], s55 offen lds
    s_waitcnt vmcnt(12) lgkmcnt(2)
    v_mfma_f32_32x32x16_bf16 v[96:111], v[216:219], v[184:187], v[96:111]
    ds_read_b64_tr_b16 v[224:225], v25 offset:24576
    ds_read_b64_tr_b16 v[226:227], v25 offset:25600
    ds_read_b64_tr_b16 v[228:229], v25 offset:24832
    ds_read_b64_tr_b16 v[230:231], v25 offset:25856
    s_waitcnt lgkmcnt(4)
    v_mfma_f32_32x32x16_bf16 v[112:127], v[220:223], v[184:187], v[112:127]
    buffer_load_dwordx4 v6, s[16:19], s55 offen offset:1024 lds
    s_waitcnt vmcnt(12)
    v_mfma_f32_32x32x16_bf16 v[128:143], v[216:219], v[188:191], v[128:143]
    v_mfma_f32_32x32x16_bf16 v[144:159], v[220:223], v[188:191], v[144:159]
    s_add_u32 s60, s72, 4096
    buffer_load_dwordx4 v[168:171], v3, s[20:23], s60 offen offset:0 sc1
    s_waitcnt vmcnt(12) lgkmcnt(2)
    v_mfma_f32_32x32x16_bf16 v[96:111], v[224:227], v[192:195], v[96:111]
    ds_read_b64_tr_b16 v[216:217], v25 offset:32768
    ds_read_b64_tr_b16 v[218:219], v25 offset:33792
    ds_read_b64_tr_b16 v[220:221], v25 offset:33024
    ds_read_b64_tr_b16 v[222:223], v25 offset:34048
    s_waitcnt lgkmcnt(4)
    v_mfma_f32_32x32x16_bf16 v[112:127], v[228:231], v[192:195], v[112:127]
    s_add_u32 m0, s81, 40960
    s_add_u32 s55, s67, 172032
    buffer_load_dwordx4 v5, s[16:19], s55 offen lds
    s_waitcnt vmcnt(12)
    v_mfma_f32_32x32x16_bf16 v[128:143], v[224:227], v[196:199], v[128:143]
    v_mfma_f32_32x32x16_bf16 v[144:159], v[228:231], v[196:199], v[144:159]
    buffer_load_dwordx4 v6, s[16:19], s55 offen offset:1024 lds
    s_waitcnt vmcnt(12) lgkmcnt(2)
    v_mfma_f32_32x32x16_bf16 v[96:111], v[216:219], v[200:203], v[96:111]
    s_barrier
    ds_read_b64_tr_b16 v[224:225], v25 offset:40960
    ds_read_b64_tr_b16 v[226:227], v25 offset:41984
    ds_read_b64_tr_b16 v[228:229], v25 offset:41216
    ds_read_b64_tr_b16 v[230:231], v25 offset:42240
    s_waitcnt lgkmcnt(4)
    v_mfma_f32_32x32x16_bf16 v[112:127], v[220:223], v[200:203], v[112:127]
    buffer_load_dwordx4 v[172:175], v3, s[20:23], s60 offen offset:1024 sc1
    s_waitcnt vmcnt(12)
    v_mfma_f32_32x32x16_bf16 v[128:143], v[216:219], v[204:207], v[128:143]
    v_mfma_f32_32x32x16_bf16 v[144:159], v[220:223], v[204:207], v[144:159]
    s_add_u32 m0, s81, 49152
    s_add_u32 s55, s67, 262144
    buffer_load_dwordx4 v5, s[84:87], s55 offen lds
    s_waitcnt vmcnt(12) lgkmcnt(2)
    v_mfma_f32_32x32x16_bf16 v[96:111], v[224:227], v[208:211], v[96:111]
    ds_read_b64_tr_b16 v[32:33], v24 offset:0
    ds_read_b64_tr_b16 v[34:35], v24 offset:1024
    ds_read_b64_tr_b16 v[36:37], v24 offset:256
    ds_read_b64_tr_b16 v[38:39], v24 offset:1280
    s_waitcnt lgkmcnt(4)
    v_mfma_f32_32x32x16_bf16 v[112:127], v[228:231], v[208:211], v[112:127]
    buffer_load_dwordx4 v6, s[84:87], s55 offen offset:1024 lds
    s_waitcnt vmcnt(12)
    v_mfma_f32_32x32x16_bf16 v[128:143], v[224:227], v[212:215], v[128:143]
    ds_read_b64_tr_b16 v[40:41], v24 offset:8192
    ds_read_b64_tr_b16 v[42:43], v24 offset:9216
    ds_read_b64_tr_b16 v[44:45], v24 offset:8448
    ds_read_b64_tr_b16 v[46:47], v24 offset:9472
    v_mfma_f32_32x32x16_bf16 v[144:159], v[228:231], v[212:215], v[144:159]
    s_add_u32 s60, s72, 10240
    buffer_load_dwordx4 v[176:179], v3, s[20:23], s60 offen offset:0 sc1
    s_waitcnt vmcnt(12) lgkmcnt(6)
    v_mfma_f32_32x32x16_bf16 v[96:111], v[32:35], v[160:163], v[96:111]
    ds_read_b64_tr_b16 v[48:49], v24 offset:16384
    ds_read_b64_tr_b16 v[50:51], v24 offset:17408
    ds_read_b64_tr_b16 v[52:53], v24 offset:16640
    ds_read_b64_tr_b16 v[54:55], v24 offset:17664
    s_waitcnt lgkmcnt(8)
    v_mfma_f32_32x32x16_bf16 v[112:127], v[36:39], v[160:163], v[112:127]
    s_add_u32 m0, s81, 57344
    s_add_u32 s55, s67, 270336
    buffer_load_dwordx4 v5, s[84:87], s55 offen lds
    buffer_load_dwordx4 v6, s[84:87], s55 offen offset:1024 lds
    buffer_load_dwordx4 v[180:183], v3, s[20:23], s60 offen offset:1024 sc1
    s_waitcnt vmcnt(12) lgkmcnt(6)
    v_mfma_f32_32x32x16_bf16 v[96:111], v[40:43], v[164:167], v[96:111]
    ds_read_b64_tr_b16 v[56:57], v24 offset:24576
    ds_read_b64_tr_b16 v[58:59], v24 offset:25600
    ds_read_b64_tr_b16 v[60:61], v24 offset:24832
    ds_read_b64_tr_b16 v[62:63], v24 offset:25856
    s_waitcnt lgkmcnt(8)
    v_mfma_f32_32x32x16_bf16 v[112:127], v[44:47], v[164:167], v[112:127]
    s_add_u32 s60, s72, 16384
    buffer_load_dwordx4 v[184:187], v3, s[88:91], s60 offen offset:0 sc1
    buffer_load_dwordx4 v[188:191], v3, s[88:91], s60 offen offset:1024 sc1
    s_add_u32 s60, s43, 2048
    buffer_load_dwordx4 v[192:195], v26, s[20:23], s60 offen offset:0 sc1
    s_waitcnt vmcnt(12) lgkmcnt(6)
    v_mfma_f32_32x32x16_bf16 v[96:111], v[48:51], v[168:171], v[96:111]
    ds_read_b64_tr_b16 v[64:65], v24 offset:32768
    ds_read_b64_tr_b16 v[66:67], v24 offset:33792
    ds_read_b64_tr_b16 v[68:69], v24 offset:33024
    ds_read_b64_tr_b16 v[70:71], v24 offset:34048
    s_waitcnt lgkmcnt(8)
    v_mfma_f32_32x32x16_bf16 v[112:127], v[52:55], v[168:171], v[112:127]
    buffer_load_dwordx4 v[196:199], v26, s[20:23], s60 offen offset:1024 sc1
    s_add_u32 s60, s72, 4096
    buffer_load_dwordx4 v[200:203], v26, s[20:23], s60 offen offset:0 sc1
    buffer_load_dwordx4 v[204:207], v26, s[20:23], s60 offen offset:1024 sc1
    s_waitcnt vmcnt(12) lgkmcnt(6)
    v_mfma_f32_32x32x16_bf16 v[96:111], v[56:59], v[172:175], v[96:111]
    ds_read_b64_tr_b16 v[72:73], v24 offset:40960
    ds_read_b64_tr_b16 v[74:75], v24 offset:41984
    ds_read_b64_tr_b16 v[76:77], v24 offset:41216
    ds_read_b64_tr_b16 v[78:79], v24 offset:42240
    s_waitcnt lgkmcnt(8)
    v_mfma_f32_32x32x16_bf16 v[112:127], v[60:63], v[172:175], v[112:127]
    s_add_u32 s60, s72, 10240
    buffer_load_dwordx4 v[208:211], v26, s[20:23], s60 offen offset:0 sc1
    buffer_load_dwordx4 v[212:215], v26, s[20:23], s60 offen offset:1024 sc1
    s_add_u32 s60, s72, 16384
    buffer_load_dwordx4 v[160:163], v26, s[88:91], s60 offen offset:0 sc1
    s_waitcnt vmcnt(12) lgkmcnt(6)
    v_mfma_f32_32x32x16_bf16 v[96:111], v[64:67], v[176:179], v[96:111]
    ds_read_b64_tr_b16 v[80:81], v24 offset:49152
    ds_read_b64_tr_b16 v[82:83], v24 offset:50176
    ds_read_b64_tr_b16 v[84:85], v24 offset:49408
    ds_read_b64_tr_b16 v[86:87], v24 offset:50432
    s_waitcnt lgkmcnt(8)
    v_mfma_f32_32x32x16_bf16 v[112:127], v[68:71], v[176:179], v[112:127]
    buffer_load_dwordx4 v[164:167], v26, s[88:91], s60 offen offset:1024 sc1
    s_waitcnt vmcnt(10) lgkmcnt(6)
    v_mfma_f32_32x32x16_bf16 v[96:111], v[72:75], v[180:183], v[96:111]
    ds_read_b64_tr_b16 v[88:89], v24 offset:57344
    ds_read_b64_tr_b16 v[90:91], v24 offset:58368
    ds_read_b64_tr_b16 v[92:93], v24 offset:57600
    ds_read_b64_tr_b16 v[94:95], v24 offset:58624
    s_waitcnt lgkmcnt(8)
    v_mfma_f32_32x32x16_bf16 v[112:127], v[76:79], v[180:183], v[112:127]
    s_waitcnt vmcnt(9) lgkmcnt(6)
    v_mfma_f32_32x32x16_bf16 v[96:111], v[80:83], v[184:187], v[96:111]
    s_waitcnt lgkmcnt(4)
    v_mfma_f32_32x32x16_bf16 v[112:127], v[84:87], v[184:187], v[112:127]
    s_waitcnt vmcnt(8) lgkmcnt(2)
    v_mfma_f32_32x32x16_bf16 v[96:111], v[88:91], v[188:191], v[96:111]
    s_waitcnt lgkmcnt(0)
    v_mfma_f32_32x32x16_bf16 v[112:127], v[92:95], v[188:191], v[112:127]
    s_waitcnt vmcnt(7)
    v_mfma_f32_32x32x16_bf16 v[128:143], v[32:35], v[192:195], v[128:143]
    v_mfma_f32_32x32x16_bf16 v[144:159], v[36:39], v[192:195], v[144:159]
    s_waitcnt vmcnt(6)
    v_mfma_f32_32x32x16_bf16 v[128:143], v[40:43], v[196:199], v[128:143]
    s_nop 4
    ds_write_b128 v16, v[96:99] offset:0
    v_mfma_f32_32x32x16_bf16 v[144:159], v[44:47], v[196:199], v[144:159]
    ds_write_b128 v17, v[100:103] offset:0
    s_waitcnt vmcnt(5)
    v_mfma_f32_32x32x16_bf16 v[128:143], v[48:51], v[200:203], v[128:143]
    ds_write_b128 v18, v[104:107] offset:0
    v_mfma_f32_32x32x16_bf16 v[144:159], v[52:55], v[200:203], v[144:159]
    ds_write_b128 v19, v[108:111] offset:0
    s_waitcnt vmcnt(4)
    v_mfma_f32_32x32x16_bf16 v[128:143], v[56:59], v[204:207], v[128:143]
    ds_write_b128 v20, v[112:115] offset:0
    v_mfma_f32_32x32x16_bf16 v[144:159], v[60:63], v[204:207], v[144:159]
    ds_write_b128 v21, v[116:119] offset:0
    s_waitcnt vmcnt(3)
    v_mfma_f32_32x32x16_bf16 v[128:143], v[64:67], v[208:211], v[128:143]
    ds_write_b128 v22, v[120:123] offset:0
    v_mfma_f32_32x32x16_bf16 v[144:159], v[68:71], v[208:211], v[144:159]
    ds_write_b128 v23, v[124:127] offset:0
    s_waitcnt vmcnt(2)
    v_mfma_f32_32x32x16_bf16 v[128:143], v[72:75], v[212:215], v[128:143]
    v_mfma_f32_32x32x16_bf16 v[144:159], v[76:79], v[212:215], v[144:159]
    s_waitcnt lgkmcnt(0)
    s_barrier
    s_waitcnt vmcnt(1)
    v_mfma_f32_32x32x16_bf16 v[128:143], v[80:83], v[160:163], v[128:143]
    v_mfma_f32_32x32x16_bf16 v[144:159], v[84:87], v[160:163], v[144:159]
    s_waitcnt vmcnt(0)
    v_mfma_f32_32x32x16_bf16 v[128:143], v[88:91], v[164:167], v[128:143]
    v_mfma_f32_32x32x16_bf16 v[144:159], v[92:95], v[164:167], v[144:159]
    s_nop 10
    ds_write_b128 v16, v[128:131] offset:32768
    ds_write_b128 v17, v[132:135] offset:32768
    ds_write_b128 v18, v[136:139] offset:32768
    ds_write_b128 v19, v[140:143] offset:32768
    ds_write_b128 v20, v[144:147] offset:32768
    ds_write_b128 v21, v[148:151] offset:32768
    ds_write_b128 v22, v[152:155] offset:32768
    ds_write_b128 v23, v[156:159] offset:32768
    s_waitcnt lgkmcnt(0)
    s_barrier
    s_endpgm
M_STRETRY:
    buffer_load_dwordx4 v[36:39], v79, s[20:23], s62 offen sc1
    buffer_load_dword v27, v86, s[20:23], s63 offen sc1
    s_add_u32 s65, s65, 1
    s_cmp_gt_u32 s65, 200000
    s_waitcnt vmcnt(0)
    s_cbranch_scc1 M_STOK
    s_branch M_STCHK
M_STRETRYL:
    buffer_load_dwordx4 v[36:39], v79, s[20:23], s62 offen sc1
    buffer_load_dword v27, v86, s[20:23], s63 offen sc1
    s_add_u32 s65, s65, 1
    s_cmp_gt_u32 s65, 200000
    s_waitcnt vmcnt(0)
    s_cbranch_scc1 M_STOKL
    s_branch M_STCHKL
M_HRETRY0:
    buffer_load_dword v27, v29, s[20:23], s73 offen offset:0 sc1
    s_add_u32 s65, s65, 1
    s_cmp_gt_u32 s65, 200000
    s_waitcnt vmcnt(0)
    s_cbranch_scc1 M_HOK0
    v_cmp_ne_u32 vcc, v27, v4
    s_cbranch_vccnz M_HRETRY0
    s_branch M_HOK0
M_HRETRY1:
    buffer_load_dword v28, v29, s[20:23], s73 offen offset:128 sc1
    s_add_u32 s65, s65, 1
    s_cmp_gt_u32 s65, 200000
    s_waitcnt vmcnt(0)
    s_cbranch_scc1 M_HOK1
    v_cmp_ne_u32 vcc, v28, v4
    s_cbranch_vccnz M_HRETRY1
    s_branch M_HOK1
M_G1L:
    s_barrier
    ds_read_b128 v[148:151], v66 offset:0
    ds_read_b64_tr_b16 v[156:157], v70 offset:0
    ds_read_b64_tr_b16 v[158:159], v70 offset:768
    ds_read_b128 v[152:155], v66 offset:2048
    ds_read_b64_tr_b16 v[160:161], v71 offset:0
    ds_read_b64_tr_b16 v[162:163], v71 offset:768
    ds_read_b64_tr_b16 v[164:165], v70 offset:256
    ds_read_b64_tr_b16 v[166:167], v70 offset:1024
    ds_read_b64_tr_b16 v[168:169], v71 offset:256
    ds_read_b64_tr_b16 v[170:171], v71 offset:1024
    s_waitcnt lgkmcnt(7)
    v_mfma_f32_16x16x32_bf16 v[88:91], v[156:159], v[148:151], 0
    ds_read_b128 v[180:183], v67 offset:0
    s_waitcnt lgkmcnt(7)
    v_mfma_f32_16x16x32_bf16 v[96:99], v[156:159], v[152:155], 0
    ds_read_b64_tr_b16 v[188:189], v72 offset:0
    ds_read_b64_tr_b16 v[190:191], v72 offset:768
    s_waitcnt lgkmcnt(7)
    v_mfma_f32_16x16x32_bf16 v[92:95], v[160:163], v[148:151], 0
    ds_read_b128 v[184:187], v67 offset:2048
    v_mfma_f32_16x16x32_bf16 v[100:103], v[160:163], v[152:155], 0
    ds_read_b64_tr_b16 v[192:193], v73 offset:0
    ds_read_b64_tr_b16 v[194:195], v73 offset:768
    s_waitcnt lgkmcnt(8)
    v_mfma_f32_16x16x32_bf16 v[104:107], v[164:167], v[148:151], 0
    ds_read_b64_tr_b16 v[196:197], v72 offset:256
    v_mfma_f32_16x16x32_bf16 v[112:115], v[164:167], v[152:155], 0
    ds_read_b64_tr_b16 v[198:199], v72 offset:1024
    s_waitcnt lgkmcnt(8)
    v_mfma_f32_16x16x32_bf16 v[108:111], v[168:171], v[148:151], 0
    ds_read_b64_tr_b16 v[200:201], v73 offset:256
    v_mfma_f32_16x16x32_bf16 v[116:119], v[168:171], v[152:155], 0
    ds_read_b64_tr_b16 v[202:203], v73 offset:1024
    s_bitcmp1_b32 s3, 1
    s_cbranch_scc1 M_CS3001
    v_mfma_f32_16x16x32_bf16 v[136:139], v[80:83], v[156:159], 0
    v_mfma_f32_16x16x32_bf16 v[140:143], v[80:83], v[160:163], 0
    v_mfma_f32_16x16x32_bf16 v[144:147], v[80:83], v[164:167], 0
    s_branch M_CS3002
M_CS3001:
    v_mfma_f32_16x16x32_bf16 v[136:139], v[80:83], v[168:171], 0
M_CS3002:
    s_waitcnt lgkmcnt(4)
    v_mfma_f32_16x16x32_bf16 v[88:91], v[188:191], v[180:183], v[88:91]
    s_waitcnt vmcnt(2)
    s_waitcnt lgkmcnt(0)
    s_barrier
    s_cmp_lg_u32 s3, 0
    s_cbranch_scc1 M_A3003
    s_mov_b64 exec, 0xff
    buffer_store_dwordx4 v[12:15], v3, s[20:23], s64 offen sc1
    s_mov_b64 exec, -1
M_A3003:
    ds_read_b128 v[148:151], v66 offset:28672
    v_mfma_f32_16x16x32_bf16 v[96:99], v[188:191], v[184:187], v[96:99]
    ds_read_b64_tr_b16 v[156:157], v70 offset:28672
    ds_read_b64_tr_b16 v[158:159], v70 offset:29440
    v_mfma_f32_16x16x32_bf16 v[92:95], v[192:195], v[180:183], v[92:95]
    ds_read_b128 v[152:155], v66 offset:30720
    v_mfma_f32_16x16x32_bf16 v[100:103], v[192:195], v[184:187], v[100:103]
    ds_read_b64_tr_b16 v[160:161], v71 offset:28672
    ds_read_b64_tr_b16 v[162:163], v71 offset:29440
    v_mfma_f32_16x16x32_bf16 v[104:107], v[196:199], v[180:183], v[104:107]
    ds_read_b64_tr_b16 v[164:165], v70 offset:28928
    v_mfma_f32_16x16x32_bf16 v[112:115], v[196:199], v[184:187], v[112:115]
    ds_read_b64_tr_b16 v[166:167], v70 offset:29696
    v_mfma_f32_16x16x32_bf16 v[108:111], v[200:203], v[180:183], v[108:111]
    ds_read_b64_tr_b16 v[168:169], v71 offset:28928
    v_mfma_f32_16x16x32_bf16 v[116:119], v[200:203], v[184:187], v[116:119]
    ds_read_b64_tr_b16 v[170:171], v71 offset:29696
    s_waitcnt lgkmcnt(4)
    v_mfma_f32_16x16x32_bf16 v[88:91], v[156:159], v[148:151], v[88:91]
    ds_read_b128 v[180:183], v67 offset:28672
    v_mfma_f32_16x16x32_bf16 v[96:99], v[156:159], v[152:155], v[96:99]
    ds_read_b64_tr_b16 v[188:189], v72 offset:28672
    ds_read_b64_tr_b16 v[190:191], v72 offset:29440
    v_mfma_f32_16x16x32_bf16 v[92:95], v[160:163], v[148:151], v[92:95]
    ds_read_b128 v[184:187], v67 offset:30720
    v_mfma_f32_16x16x32_bf16 v[100:103], v[160:163], v[152:155], v[100:103]
    ds_read_b64_tr_b16 v[192:193], v73 offset:28672
    ds_read_b64_tr_b16 v[194:195], v73 offset:29440
    s_waitcnt lgkmcnt(6)
    v_mfma_f32_16x16x32_bf16 v[104:107], v[164:167], v[148:151], v[104:107]
    ds_read_b64_tr_b16 v[196:197], v72 offset:28928
    v_mfma_f32_16x16x32_bf16 v[112:115], v[164:167], v[152:155], v[112:115]
    ds_read_b64_tr_b16 v[198:199], v72 offset:29696
    v_mfma_f32_16x16x32_bf16 v[108:111], v[168:171], v[148:151], v[108:111]
    ds_read_b64_tr_b16 v[200:201], v73 offset:28928
    v_mfma_f32_16x16x32_bf16 v[116:119], v[168:171], v[152:155], v[116:119]
    ds_read_b64_tr_b16 v[202:203], v73 offset:29696
    s_bitcmp1_b32 s3, 1
    s_cbranch_scc1 M_CS3004
    v_mfma_f32_16x16x32_bf16 v[136:139], v[80:83], v[156:159], v[136:139]
    v_mfma_f32_16x16x32_bf16 v[140:143], v[80:83], v[160:163], v[140:143]
    v_mfma_f32_16x16x32_bf16 v[144:147], v[80:83], v[164:167], v[144:147]
    s_branch M_CS3005
M_CS3004:
    v_mfma_f32_16x16x32_bf16 v[136:139], v[80:83], v[168:171], v[136:139]
M_CS3005:
    s_waitcnt lgkmcnt(4)
    v_mfma_f32_16x16x32_bf16 v[88:91], v[188:191], v[180:183], v[88:91]
    s_waitcnt lgkmcnt(0)
    s_barrier
    ds_read_b128 v[148:151], v68 offset:0
    v_mfma_f32_16x16x32_bf16 v[96:99], v[188:191], v[184:187], v[96:99]
    ds_read_b64_tr_b16 v[156:157], v74 offset:0
    ds_read_b64_tr_b16 v[158:159], v74 offset:768
    v_mfma_f32_16x16x32_bf16 v[92:95], v[192:195], v[180:183], v[92:95]
    ds_read_b128 v[152:155], v68 offset:2048
    v_mfma_f32_16x16x32_bf16 v[100:103], v[192:195], v[184:187], v[100:103]
    ds_read_b64_tr_b16 v[160:161], v75 offset:0
    ds_read_b64_tr_b16 v[162:163], v75 offset:768
    v_mfma_f32_16x16x32_bf16 v[104:107], v[196:199], v[180:183], v[104:107]
    ds_read_b64_tr_b16 v[164:165], v74 offset:256
    v_mfma_f32_16x16x32_bf16 v[112:115], v[196:199], v[184:187], v[112:115]
    ds_read_b64_tr_b16 v[166:167], v74 offset:1024
    v_mfma_f32_16x16x32_bf16 v[108:111], v[200:203], v[180:183], v[108:111]
    ds_read_b64_tr_b16 v[168:169], v75 offset:256
    v_mfma_f32_16x16x32_bf16 v[116:119], v[200:203], v[184:187], v[116:119]
    ds_read_b64_tr_b16 v[170:171], v75 offset:1024
    s_waitcnt lgkmcnt(4)
    v_mfma_f32_16x16x32_bf16 v[88:91], v[156:159], v[148:151], v[88:91]
    ds_read_b128 v[180:183], v69 offset:0
    v_mfma_f32_16x16x32_bf16 v[96:99], v[156:159], v[152:155], v[96:99]
    ds_read_b64_tr_b16 v[188:189], v76 offset:0
    ds_read_b64_tr_b16 v[190:191], v76 offset:768
    v_mfma_f32_16x16x32_bf16 v[92:95], v[160:163], v[148:151], v[92:95]
    ds_read_b128 v[184:187], v69 offset:2048
    v_mfma_f32_16x16x32_bf16 v[100:103], v[160:163], v[152:155], v[100:103]
    ds_read_b64_tr_b16 v[192:193], v77 offset:0
    ds_read_b64_tr_b16 v[194:195], v77 offset:768
    s_waitcnt lgkmcnt(6)
    v_mfma_f32_16x16x32_bf16 v[104:107], v[164:167], v[148:151], v[104:107]
    ds_read_b64_tr_b16 v[196:197], v76 offset:256
    v_mfma_f32_16x16x32_bf16 v[112:115], v[164:167], v[152:155], v[112:115]
    ds_read_b64_tr_b16 v[198:199], v76 offset:1024
    v_mfma_f32_16x16x32_bf16 v[108:111], v[168:171], v[148:151], v[108:111]
    ds_read_b64_tr_b16 v[200:201], v77 offset:256
    v_mfma_f32_16x16x32_bf16 v[116:119], v[168:171], v[152:155], v[116:119]
    ds_read_b64_tr_b16 v[202:203], v77 offset:1024
    s_bitcmp1_b32 s3, 1
    s_cbranch_scc1 M_CS3006
    v_mfma_f32_16x16x32_bf16 v[136:139], v[80:83], v[156:159], v[136:139]
    v_mfma_f32_16x16x32_bf16 v[140:143], v[80:83], v[160:163], v[140:143]
    v_mfma_f32_16x16x32_bf16 v[144:147], v[80:83], v[164:167], v[144:147]
    s_branch M_CS3007
M_CS3006:
    v_mfma_f32_16x16x32_bf16 v[136:139], v[80:83], v[168:171], v[136:139]
M_CS3007:
    s_waitcnt lgkmcnt(4)
    v_mfma_f32_16x16x32_bf16 v[88:91], v[188:191], v[180:183], v[88:91]
    s_waitcnt lgkmcnt(0)
    s_barrier
    ds_read_b128 v[148:151], v68 offset:28672
    v_mfma_f32_16x16x32_bf16 v[96:99], v[188:191], v[184:187], v[96:99]
    ds_read_b64_tr_b16 v[156:157], v74 offset:28672
    ds_read_b64_tr_b16 v[158:159], v74 offset:29440
    v_mfma_f32_16x16x32_bf16 v[92:95], v[192:195], v[180:183], v[92:95]
    ds_read_b128 v[152:155], v68 offset:30720
    v_mfma_f32_16x16x32_bf16 v[100:103], v[192:195], v[184:187], v[100:103]
    ds_read_b64_tr_b16 v[160:161], v75 offset:28672
    ds_read_b64_tr_b16 v[162:163], v75 offset:29440
    v_mfma_f32_16x16x32_bf16 v[104:107], v[196:199], v[180:183], v[104:107]
    ds_read_b64_tr_b16 v[164:165], v74 offset:28928
    v_mfma_f32_16x16x32_bf16 v[112:115], v[196:199], v[184:187], v[112:115]
    ds_read_b64_tr_b16 v[166:167], v74 offset:29696
    v_mfma_f32_16x16x32_bf16 v[108:111], v[200:203], v[180:183], v[108:111]
    ds_read_b64_tr_b16 v[168:169], v75 offset:28928
    v_mfma_f32_16x16x32_bf16 v[116:119], v[200:203], v[184:187], v[116:119]
    ds_read_b64_tr_b16 v[170:171], v75 offset:29696
    s_waitcnt lgkmcnt(4)
    v_mfma_f32_16x16x32_bf16 v[88:91], v[156:159], v[148:151], v[88:91]
    ds_read_b128 v[180:183], v69 offset:28672
    v_and_b32 v8, 15, v1
    v_mfma_f32_16x16x32_bf16 v[96:99], v[156:159], v[152:155], v[96:99]
    ds_read_b64_tr_b16 v[188:189], v76 offset:28672
    ds_read_b64_tr_b16 v[190:191], v76 offset:29440
    v_mfma_f32_16x16x32_bf16 v[92:95], v[160:163], v[148:151], v[92:95]
    ds_read_b128 v[184:187], v69 offset:30720
    v_lshlrev_b32 v8, 1, v8
    v_mfma_f32_16x16x32_bf16 v[100:103], v[160:163], v[152:155], v[100:103]
    ds_read_b64_tr_b16 v[192:193], v77 offset:28672
    ds_read_b64_tr_b16 v[194:195], v77 offset:29440
    s_waitcnt lgkmcnt(6)
    v_mfma_f32_16x16x32_bf16 v[104:107], v[164:167], v[148:151], v[104:107]
    ds_read_b64_tr_b16 v[196:197], v76 offset:28928
    v_add_u32 v8, 160064, v8
    v_mfma_f32_16x16x32_bf16 v[112:115], v[164:167], v[152:155], v[112:115]
    ds_read_b64_tr_b16 v[198:199], v76 offset:29696
    ds_read_u16 v42, v8 offset:0
    v_mfma_f32_16x16x32_bf16 v[108:111], v[168:171], v[148:151], v[108:111]
    ds_read_b64_tr_b16 v[200:201], v77 offset:28928
    v_mov_b32 v43, 0
    v_mfma_f32_16x16x32_bf16 v[116:119], v[168:171], v[152:155], v[116:119]
    ds_read_b64_tr_b16 v[202:203], v77 offset:29696
    s_bitcmp1_b32 s3, 1
    s_cbranch_scc1 M_CS3008
    v_mfma_f32_16x16x32_bf16 v[136:139], v[80:83], v[156:159], v[136:139]
    v_mfma_f32_16x16x32_bf16 v[140:143], v[80:83], v[160:163], v[140:143]
    v_mfma_f32_16x16x32_bf16 v[144:147], v[80:83], v[164:167], v[144:147]
    s_branch M_CS3009
M_CS3008:
    v_mfma_f32_16x16x32_bf16 v[136:139], v[80:83], v[168:171], v[136:139]
M_CS3009:
    s_waitcnt lgkmcnt(5)
    v_mfma_f32_16x16x32_bf16 v[88:91], v[188:191], v[180:183], v[88:91]
    ds_read_u16 v46, v8 offset:32
    v_mov_b32 v47, 0
    ds_read_u16 v50, v8 offset:64
    v_mov_b32 v51, 0
    s_waitcnt lgkmcnt(0)
    s_barrier
    buffer_load_dwordx4 v[36:39], v79, s[20:23], s62 offen sc1
    buffer_load_dword v27, v86, s[20:23], s63 offen sc1
    ds_read_b128 v[148:151], v66 offset:0
    ds_read_u16 v54, v8 offset:96
    v_mfma_f32_16x16x32_bf16 v[96:99], v[188:191], v[184:187], v[96:99]
    ds_read_b64_tr_b16 v[156:157], v70 offset:0
    ds_read_b64_tr_b16 v[158:159], v70 offset:768
    v_mfma_f32_16x16x32_bf16 v[92:95], v[192:195], v[180:183], v[92:95]
    ds_read_b128 v[152:155], v66 offset:2048
    v_mov_b32 v55, 0
    v_mfma_f32_16x16x32_bf16 v[100:103], v[192:195], v[184:187], v[100:103]
    ds_read_b64_tr_b16 v[160:161], v71 offset:0
    ds_read_b64_tr_b16 v[162:163], v71 offset:768
    v_mfma_f32_16x16x32_bf16 v[104:107], v[196:199], v[180:183], v[104:107]
    ds_read_b64_tr_b16 v[164:165], v70 offset:256
    ds_read_u16 v58, v8 offset:128
    v_mfma_f32_16x16x32_bf16 v[112:115], v[196:199], v[184:187], v[112:115]
    ds_read_b64_tr_b16 v[166:167], v70 offset:1024
    v_mov_b32 v59, 0
    v_mfma_f32_16x16x32_bf16 v[108:111], v[200:203], v[180:183], v[108:111]
    ds_read_b64_tr_b16 v[168:169], v71 offset:256
    ds_read_u16 v62, v8 offset:160
    v_mfma_f32_16x16x32_bf16 v[116:119], v[200:203], v[184:187], v[116:119]
    ds_read_b64_tr_b16 v[170:171], v71 offset:1024
    v_mov_b32 v63, 0
    s_waitcnt lgkmcnt(6)
    v_mfma_f32_16x16x32_bf16 v[88:91], v[156:159], v[148:151], v[88:91]
    ds_read_b128 v[180:183], v67 offset:0
    v_lshl_or_b32 v42, v42, 16, v42
    v_mfma_f32_16x16x32_bf16 v[96:99], v[156:159], v[152:155], v[96:99]
    ds_read_b64_tr_b16 v[188:189], v72 offset:0
    ds_read_b64_tr_b16 v[190:191], v72 offset:768
    v_mfma_f32_16x16x32_bf16 v[92:95], v[160:163], v[148:151], v[92:95]
    ds_read_b128 v[184:187], v67 offset:2048
    v_lshl_or_b32 v46, v46, 16, v46
    v_mfma_f32_16x16x32_bf16 v[100:103], v[160:163], v[152:155], v[100:103]
    ds_read_b64_tr_b16 v[192:193], v73 offset:0
    ds_read_b64_tr_b16 v[194:195], v73 offset:768
    s_waitcnt lgkmcnt(6)
    v_mfma_f32_16x16x32_bf16 v[104:107], v[164:167], v[148:151], v[104:107]
    ds_read_b64_tr_b16 v[196:197], v72 offset:256
    v_lshl_or_b32 v50, v50, 16, v50
    v_mfma_f32_16x16x32_bf16 v[112:115], v[164:167], v[152:155], v[112:115]
    ds_read_b64_tr_b16 v[198:199], v72 offset:1024
    v_lshl_or_b32 v54, v54, 16, v54
    v_mfma_f32_16x16x32_bf16 v[108:111], v[168:171], v[148:151], v[108:111]
    ds_read_b64_tr_b16 v[200:201], v73 offset:256
    v_lshl_or_b32 v58, v58, 16, v58
    v_mfma_f32_16x16x32_bf16 v[116:119], v[168:171], v[152:155], v[116:119]
    ds_read_b64_tr_b16 v[202:203], v73 offset:1024
    s_bitcmp1_b32 s3, 1
    s_cbranch_scc1 M_CS3010
    v_mfma_f32_16x16x32_bf16 v[136:139], v[80:83], v[156:159], v[136:139]
    v_mfma_f32_16x16x32_bf16 v[140:143], v[80:83], v[160:163], v[140:143]
    v_mfma_f32_16x16x32_bf16 v[144:147], v[80:83], v[164:167], v[144:147]
    s_branch M_CS3011
M_CS3010:
    v_mfma_f32_16x16x32_bf16 v[136:139], v[80:83], v[168:171], v[136:139]
M_CS3011:
    s_waitcnt lgkmcnt(4)
    v_mfma_f32_16x16x32_bf16 v[88:91], v[188:191], v[180:183], v[88:91]
    v_lshl_or_b32 v62, v62, 16, v62
    s_waitcnt lgkmcnt(0)
    s_barrier
    ds_read_b128 v[148:151], v66 offset:28672
    v_mfma_f32_16x16x32_bf16 v[96:99], v[188:191], v[184:187], v[96:99]
    ds_read_b64_tr_b16 v[156:157], v70 offset:28672
    ds_read_b64_tr_b16 v[158:159], v70 offset:29440
    v_mfma_f32_16x16x32_bf16 v[92:95], v[192:195], v[180:183], v[92:95]
    ds_read_b128 v[152:155], v66 offset:30720
    v_mfma_f32_16x16x32_bf16 v[100:103], v[192:195], v[184:187], v[100:103]
    ds_read_b64_tr_b16 v[160:161], v71 offset:28672
    ds_read_b64_tr_b16 v[162:163], v71 offset:29440
    v_mfma_f32_16x16x32_bf16 v[104:107], v[196:199], v[180:183], v[104:107]
    ds_read_b64_tr_b16 v[164:165], v70 offset:28928
    v_mfma_f32_16x16x32_bf16 v[112:115], v[196:199], v[184:187], v[112:115]
    ds_read_b64_tr_b16 v[166:167], v70 offset:29696
    v_mfma_f32_16x16x32_bf16 v[108:111], v[200:203], v[180:183], v[108:111]
    ds_read_b64_tr_b16 v[168:169], v71 offset:28928
    v_mfma_f32_16x16x32_bf16 v[116:119], v[200:203], v[184:187], v[116:119]
    ds_read_b64_tr_b16 v[170:171], v71 offset:29696
    s_waitcnt lgkmcnt(4)
    v_mfma_f32_16x16x32_bf16 v[88:91], v[156:159], v[148:151], v[88:91]
    ds_read_b128 v[180:183], v67 offset:28672
    v_mfma_f32_16x16x32_bf16 v[96:99], v[156:159], v[152:155], v[96:99]
    ds_read_b64_tr_b16 v[188:189], v72 offset:28672
    ds_read_b64_tr_b16 v[190:191], v72 offset:29440
    v_mfma_f32_16x16x32_bf16 v[92:95], v[160:163], v[148:151], v[92:95]
    ds_read_b128 v[184:187], v67 offset:30720
    v_mfma_f32_16x16x32_bf16 v[100:103], v[160:163], v[152:155], v[100:103]
    ds_read_b64_tr_b16 v[192:193], v73 offset:28672
    ds_read_b64_tr_b16 v[194:195], v73 offset:29440
    s_waitcnt lgkmcnt(6)
    v_mfma_f32_16x16x32_bf16 v[104:107], v[164:167], v[148:151], v[104:107]
    ds_read_b64_tr_b16 v[196:197], v72 offset:28928
    v_mfma_f32_16x16x32_bf16 v[112:115], v[164:167], v[152:155], v[112:115]
    ds_read_b64_tr_b16 v[198:199], v72 offset:29696
    v_mfma_f32_16x16x32_bf16 v[108:111], v[168:171], v[148:151], v[108:111]
    ds_read_b64_tr_b16 v[200:201], v73 offset:28928
    v_mfma_f32_16x16x32_bf16 v[116:119], v[168:171], v[152:155], v[116:119]
    ds_read_b64_tr_b16 v[202:203], v73 offset:29696
    s_bitcmp1_b32 s3, 1
    s_cbranch_scc1 M_CS3012
    v_mfma_f32_16x16x32_bf16 v[136:139], v[80:83], v[156:159], v[136:139]
    v_mfma_f32_16x16x32_bf16 v[140:143], v[80:83], v[160:163], v[140:143]
    v_mfma_f32_16x16x32_bf16 v[144:147], v[80:83], v[164:167], v[144:147]
    s_branch M_CS3013
M_CS3012:
    v_mfma_f32_16x16x32_bf16 v[136:139], v[80:83], v[168:171], v[136:139]
M_CS3013:
    s_mov_b32 s65, 0
    s_waitcnt vmcnt(0)
M_STCHKL:
    v_xor_b32 v8, v37, v4
    v_xor_b32 v9, v39, v4
    v_xor_b32 v10, v27, v4
    v_or3_b32 v8, v8, v9, v10
    v_cmp_ne_u32 vcc, 0, v8
    s_cbranch_vccnz M_STRETRYL
M_STOKL:
    s_waitcnt lgkmcnt(4)
    v_mfma_f32_16x16x32_bf16 v[88:91], v[188:191], v[180:183], v[88:91]
    v_add_f32 v8, 0x3727c5ac, v38
    v_rsq_f32 v85, v8
    v_mov_b32 v215, 0
    v_mul_f32 v9, v85, v85
    s_waitcnt lgkmcnt(0)
    s_barrier
    ds_read_b128 v[148:151], v68 offset:0
    v_mul_f32 v9, v9, v38
    v_mfma_f32_16x16x32_bf16 v[96:99], v[188:191], v[184:187], v[96:99]
    ds_read_b64_tr_b16 v[156:157], v74 offset:0
    ds_read_b64_tr_b16 v[158:159], v74 offset:768
    v_mfma_f32_16x16x32_bf16 v[92:95], v[192:195], v[180:183], v[92:95]
    ds_read_b128 v[152:155], v68 offset:2048
    v_add_f32 v9, 0x3727c5ac, v9
    v_mfma_f32_16x16x32_bf16 v[100:103], v[192:195], v[184:187], v[100:103]
    ds_read_b64_tr_b16 v[160:161], v75 offset:0
    ds_read_b64_tr_b16 v[162:163], v75 offset:768
    v_mfma_f32_16x16x32_bf16 v[104:107], v[196:199], v[180:183], v[104:107]
    ds_read_b64_tr_b16 v[164:165], v74 offset:256
    v_rsq_f32 v9, v9
    v_mfma_f32_16x16x32_bf16 v[112:115], v[196:199], v[184:187], v[112:115]
    ds_read_b64_tr_b16 v[166:167], v74 offset:1024
    v_mov_b32 v219, 0
    v_mfma_f32_16x16x32_bf16 v[108:111], v[200:203], v[180:183], v[108:111]
    ds_read_b64_tr_b16 v[168:169], v75 offset:256
    v_mul_f32 v9, v9, v85
    v_mfma_f32_16x16x32_bf16 v[116:119], v[200:203], v[184:187], v[116:119]
    ds_read_b64_tr_b16 v[170:171], v75 offset:1024
    v_rcp_f32 v222, v9
    s_waitcnt lgkmcnt(4)
    v_mfma_f32_16x16x32_bf16 v[88:91], v[156:159], v[148:151], v[88:91]
    ds_read_b128 v[180:183], v69 offset:0
    v_mul_f32 v226, 0xc0135761, v9
    v_mfma_f32_16x16x32_bf16 v[96:99], v[156:159], v[152:155], v[96:99]
    ds_read_b64_tr_b16 v[188:189], v76 offset:0
    ds_read_b64_tr_b16 v[190:191], v76 offset:768
    v_mfma_f32_16x16x32_bf16 v[92:95], v[160:163], v[148:151], v[92:95]
    ds_read_b128 v[184:187], v69 offset:2048
    v_mul_f32 v8, v9, v9
    v_mfma_f32_16x16x32_bf16 v[100:103], v[160:163], v[152:155], v[100:103]
    ds_read_b64_tr_b16 v[192:193], v77 offset:0
    ds_read_b64_tr_b16 v[194:195], v77 offset:768
    s_waitcnt lgkmcnt(6)
    v_mfma_f32_16x16x32_bf16 v[104:107], v[164:167], v[148:151], v[104:107]
    ds_read_b64_tr_b16 v[196:197], v76 offset:256
    v_mul_f32 v8, 0x3d372713, v8
    v_mfma_f32_16x16x32_bf16 v[112:115], v[164:167], v[152:155], v[112:115]
    ds_read_b64_tr_b16 v[198:199], v76 offset:1024
    v_mul_f32 v64, v8, v226
    v_mfma_f32_16x16x32_bf16 v[108:111], v[168:171], v[148:151], v[108:111]
    ds_read_b64_tr_b16 v[200:201], v77 offset:256
    v_cvt_pk_bf16_f32 v8, -v36, v222
    v_mfma_f32_16x16x32_bf16 v[116:119], v[168:171], v[152:155], v[116:119]
    ds_read_b64_tr_b16 v[202:203], v77 offset:1024
    s_bitcmp1_b32 s3, 1
    s_cbranch_scc1 M_CS3014
    v_mfma_f32_16x16x32_bf16 v[136:139], v[80:83], v[156:159], v[136:139]
    v_mfma_f32_16x16x32_bf16 v[140:143], v[80:83], v[160:163], v[140:143]
    v_mfma_f32_16x16x32_bf16 v[144:147], v[80:83], v[164:167], v[144:147]
    s_branch M_CS3015
M_CS3014:
    v_mfma_f32_16x16x32_bf16 v[136:139], v[80:83], v[168:171], v[136:139]
M_CS3015:
    s_waitcnt lgkmcnt(4)
    v_mfma_f32_16x16x32_bf16 v[88:91], v[188:191], v[180:183], v[88:91]
    v_lshlrev_b32 v9, 16, v8
    v_and_b32 v10, 0xffff0000, v8
    v_mfma_f32_16x16x32_bf16 v[96:99], v[188:191], v[184:187], v[96:99]
    v_sub_f32 v212, -v36, v9
    v_sub_f32 v214, v222, v10
    v_mfma_f32_16x16x32_bf16 v[92:95], v[192:195], v[180:183], v[92:95]
    v_cvt_pk_bf16_f32 v212, v9, v212
    v_cvt_pk_bf16_f32 v214, v10, v214
    v_mfma_f32_16x16x32_bf16 v[100:103], v[192:195], v[184:187], v[100:103]
    v_mov_b32 v228, v226
    v_mov_b32 v224, v222
    v_mov_b32 v220, v64
    v_mov_b32 v216, v212
    v_mov_b32 v218, v214
    s_mov_b32 vcc_lo, 0xffff
    s_mov_b32 vcc_hi, 0
    v_permlane16_swap_b32 v226, v228
    v_permlane16_swap_b32 v222, v224
    v_permlane16_swap_b32 v64, v220
    v_permlane16_swap_b32 v212, v216
    v_permlane16_swap_b32 v214, v218
    v_mov_b32 v213, v212
    v_cndmask_b32 v214, 0, v214, vcc
    v_mov_b32 v217, v216
    v_cndmask_b32 v218, 0, v218, vcc
    s_waitcnt lgkmcnt(0)
    s_barrier
    ds_read_b128 v[148:151], v68 offset:28672
    ds_read_b64_tr_b16 v[156:157], v74 offset:28672
    v_mfma_f32_16x16x32_bf16 v[104:107], v[196:199], v[180:183], v[104:107]
    ds_read_b64_tr_b16 v[158:159], v74 offset:29440
    ds_read_b128 v[152:155], v68 offset:30720
    v_mfma_f32_16x16x32_bf16 v[112:115], v[196:199], v[184:187], v[112:115]
    ds_read_b64_tr_b16 v[160:161], v75 offset:28672
    ds_read_b64_tr_b16 v[162:163], v75 offset:29440
    v_mfma_f32_16x16x32_bf16 v[108:111], v[200:203], v[180:183], v[108:111]
    ds_read_b64_tr_b16 v[164:165], v74 offset:28928
    ds_read_b64_tr_b16 v[166:167], v74 offset:29696
    v_mfma_f32_16x16x32_bf16 v[116:119], v[200:203], v[184:187], v[116:119]
    ds_read_b64_tr_b16 v[168:169], v75 offset:28928
    ds_read_b64_tr_b16 v[170:171], v75 offset:29696
    s_waitcnt lgkmcnt(7)
    v_mfma_f32_16x16x32_bf16 v[88:91], v[156:159], v[148:151], v[88:91]
    ds_read_b128 v[180:183], v69 offset:28672
    s_waitcnt lgkmcnt(7)
    v_mfma_f32_16x16x32_bf16 v[96:99], v[156:159], v[152:155], v[96:99]
    ds_read_b64_tr_b16 v[188:189], v76 offset:28672
    ds_read_b64_tr_b16 v[190:191], v76 offset:29440
    s_waitcnt lgkmcnt(7)
    v_mfma_f32_16x16x32_bf16 v[92:95], v[160:163], v[148:151], v[92:95]
    ds_read_b128 v[184:187], v69 offset:30720
    v_mfma_f32_16x16x32_bf16 v[100:103], v[160:163], v[152:155], v[100:103]
    ds_read_b64_tr_b16 v[192:193], v77 offset:28672
    ds_read_b64_tr_b16 v[194:195], v77 offset:29440
    s_waitcnt lgkmcnt(6)
    s_bitcmp1_b32 s3, 1
    s_cbranch_scc1 M_CS3016
    v_mfma_f32_16x16x32_bf16 v[136:139], v[80:83], v[156:159], v[136:139]
    v_mfma_f32_16x16x32_bf16 v[140:143], v[80:83], v[160:163], v[140:143]
    v_mfma_f32_16x16x32_bf16 v[144:147], v[80:83], v[164:167], v[144:147]
    s_branch M_CS3017
M_CS3016:
    v_mfma_f32_16x16x32_bf16 v[136:139], v[80:83], v[168:171], v[136:139]
M_CS3017:
    v_mfma_f32_16x16x32_bf16 v[104:107], v[164:167], v[148:151], v[104:107]
    ds_read_b64_tr_b16 v[196:197], v76 offset:28928
    v_mfma_f32_16x16x32_bf16 v[112:115], v[164:167], v[152:155], v[112:115]
    ds_read_b64_tr_b16 v[198:199], v76 offset:29696
    v_mfma_f32_16x16x32_bf16 v[108:111], v[168:171], v[148:151], v[108:111]
    ds_read_b64_tr_b16 v[200:201], v77 offset:28928
    v_mfma_f32_16x16x32_bf16 v[116:119], v[168:171], v[152:155], v[116:119]
    ds_read_b64_tr_b16 v[202:203], v77 offset:29696
    ds_write_b32 v84, v136 offset:0
    ds_write_b32 v84, v140 offset:256
    ds_write_b32 v84, v144 offset:512
    s_waitcnt lgkmcnt(7)
    v_mfma_f32_16x16x32_bf16 v[88:91], v[188:191], v[180:183], v[88:91]
    v_mfma_f32_16x16x32_bf16 v[96:99], v[188:191], v[184:187], v[96:99]
    v_mfma_f32_16x16x32_bf16 v[92:95], v[192:195], v[180:183], v[92:95]
    v_mfma_f32_16x16x32_bf16 v[100:103], v[192:195], v[184:187], v[100:103]
    s_waitcnt lgkmcnt(3)
    v_mfma_f32_16x16x32_bf16 v[104:107], v[196:199], v[180:183], v[104:107]
    s_waitcnt lgkmcnt(0)
    s_barrier
    ds_read_b32 v41, v87 offset:0
    ds_read_b32 v45, v87 offset:256
    ds_read_b32 v49, v87 offset:512
    ds_read_b32 v53, v87 offset:768
    ds_read_b32 v57, v87 offset:1024
    ds_read_b32 v61, v87 offset:1280
    v_mfma_f32_16x16x32_bf16 v[112:115], v[196:199], v[184:187], v[112:115]
    v_mfma_f32_16x16x32_bf16 v[108:111], v[200:203], v[180:183], v[108:111]
    v_mfma_f32_16x16x32_bf16 v[116:119], v[200:203], v[184:187], v[116:119]
    s_waitcnt lgkmcnt(0)
    s_nop 7
    s_branch M_G1E
.p2align 12
.globl parallel_sum__ssm_conv_h3__mixer_channel_mlp__prompt_kernel
.p2align 8
.type parallel_sum__ssm_conv_h3__mixer_channel_mlp__prompt_kernel,@function
parallel_sum__ssm_conv_h3__mixer_channel_mlp__prompt_kernel:
    s_load_dwordx2 s[8:9], s[0:1], 0
    s_load_dwordx2 s[20:21], s[0:1], 104
    s_load_dwordx2 s[12:13], s[0:1], 56
    s_cmp_ge_u32 s2, 256
    s_cbranch_scc1 L_END
    v_readfirstlane_b32 s64, v0
    s_mov_b32 s10, 2097152
    s_mov_b32 s11, 0x20000
    s_mov_b32 s22, 268435456
    s_mov_b32 s23, 0x20000
    s_mov_b32 s14, 1409024
    s_mov_b32 s15, 0x20000
    v_and_b32 v1, 63, v0
    v_lshlrev_b32 v3, 4, v1
    s_bfe_u32 s3, s64, 0x20006
    s_and_b32 s4, s2, 7
    s_lshr_b32 s5, s2, 3
    s_and_b32 s6, s2, 1
    s_lshr_b32 s7, s2, 5
    s_bfe_u32 s78, s2, 0x20003
    s_and_b32 s52, s2, 6
    s_lshl_b32 s52, s52, 1
    s_add_u32 s52, s52, s78
    s_lshl_b32 s53, s6, 3
    s_add_u32 s53, s53, s7
    s_mul_i32 s54, s53, 3
    s_lshr_b32 s60, s53, 2
    s_sub_u32 s54, s54, s60
    s_min_u32 s54, s54, 41
    s_cmp_ge_u32 s64, 256
    s_cbranch_scc1 L_C
    s_load_dwordx2 s[24:25], s[0:1], 8
    s_mov_b32 s26, 2097152
    s_mov_b32 s27, 0x20000
    s_load_dwordx2 s[28:29], s[0:1], 16
    s_mov_b32 s30, 2097152
    s_mov_b32 s31, 0x20000
    s_load_dwordx2 s[44:45], s[0:1], 24
    v_lshrrev_b32 v7, 5, v1
    v_bfe_u32 v8, v1, 2, 2
    v_lshl_add_u32 v7, v7, 2, v8
    v_and_b32 v8, 48, v3
    v_lshl_or_b32 v5, v7, 10, v8
    v_and_b32 v7, 16, v1
    v_lshl_or_b32 v5, v7, 2, v5
    v_add_u32 v6, 7168, v5
    s_lshl_b32 s62, s5, 2
    s_add_u32 s77, s62, s3
    s_lshl_b32 s62, s77, 14
    s_lshl_b32 s63, s4, 7
    s_add_u32 s62, s62, s63
    s_sub_u32 s60, s62, 8192
    v_add_u32 v9, s60, v5
    s_mul_i32 s64, s3, 5120
    s_add_u32 s64, s64, 114688
    s_lshl_b32 s63, s4, 9
    v_lshl_add_u32 v10, v1, 3, s63
    s_lshl_b32 s76, s52, 4
    s_add_u32 s76, s76, s53
    s_lshl_b32 s76, s76, 2
    s_add_u32 s76, s76, s3
    s_lshl_b32 s63, s76, 11
    s_lshl_b32 s60, s2, 2
    s_add_u32 s60, s60, s3
    s_mul_i32 s60, s60, 1408
    v_lshl_add_u32 v7, v1, 7, s60
    s_mov_b32 m0, s64
    s_waitcnt lgkmcnt(0)
    buffer_load_dwordx4 v[32:35], v3, s[8:11], s63 offen
    buffer_load_dwordx4 v[36:39], v3, s[8:11], s63 offen offset:1024
    s_mov_b64 exec, 2047
    buffer_load_dword v40, v7, s[12:15], 0 offen
    s_mov_b32 exec_hi, -1
    s_mov_b32 exec_lo, 0
    buffer_load_dwordx4 v9, s[24:27], 0 offen lds
    s_mov_b32 exec_lo, -1
    s_add_u32 m0, s64, 1024
    s_nop 0
    buffer_load_dwordx4 v5, s[24:27], s62 offen lds
    buffer_load_dwordx4 v6, s[24:27], s62 offen offset:1024 lds
    s_add_u32 m0, s64, 3072
    s_nop 0
    buffer_load_dwordx4 v5, s[28:31], s62 offen lds
    buffer_load_dwordx4 v6, s[28:31], s62 offen offset:1024 lds
    global_load_dwordx2 v[64:65], v10, s[44:45]
    s_buffer_load_dword s79, s[20:23], 0
    s_branch M_MAIN
L_C:
    s_setprio 3
    s_getpc_b64 s[50:51]
C_PC:
    s_sub_u32 s50, s50, C_PC-M_MAIN
    s_subb_u32 s51, s51, 0
    s_lshl_b32 s63, s5, 2
    s_add_u32 s63, s63, s3
    s_mul_i32 s63, s63, 2
    v_add_u32 v9, s63, v1
    v_lshlrev_b32 v9, 7, v9
    v_min_u32 v9, L_END-M_MAIN, v9
    s_mov_b64 exec, 3
    global_load_dword v180, v9, s[50:51]
    s_mov_b64 exec, -1
    s_mul_i32 s57, s7, 0
    s_mul_i32 s61, s78, 0
    s_add_u32 s57, s57, s61
    s_lshr_b32 s61, s4, 1
    s_mul_i32 s61, s61, 0
    s_add_u32 s57, s57, s61
    s_mul_i32 s61, s6, 0
    s_add_u32 s57, s57, s61
    s_and_b32 s57, s57, 7
    s_lshl_b32 s55, s52, 17
    s_lshl_b32 s62, s3, 15
    s_add_u32 s55, s55, s62
    s_mul_i32 s56, s3, 44032
    s_lshl_b32 s62, s54, 6
    s_add_u32 s56, s56, s62
    s_lshl_b32 s70, s3, 12
    s_mul_i32 s71, s3, 3072
    s_add_u32 s71, s71, 16384
    v_lshrrev_b32 v7, 4, v1
    v_and_b32 v8, 7, v1
    v_xor_b32 v8, v8, v7
    v_lshlrev_b32 v8, 4, v8
    v_lshrrev_b32 v9, 3, v1
    v_lshl_or_b32 v204, v9, 10, v8
    v_xor_b32 v205, 64, v204
    v_add_u32 v206, 14336, v204
    v_add_u32 v205, 7168, v205
    v_add_u32 v207, 14336, v205
    v_bfe_u32 v8, v1, 2, 2
    v_and_b32 v9, 48, v3
    v_lshl_or_b32 v9, v7, 6, v9
    s_movk_i32 s60, 2752
    v_mad_u32_u24 v10, v8, s60, v9
    s_movk_i32 s60, 10816
    v_add_u32 v8, 1, v7
    v_lshrrev_b32 v8, 2, v8
    v_mad_u32_u24 v208, v8, s60, v10
    v_add_u32 v8, 2, v7
    v_lshrrev_b32 v8, 2, v8
    v_mad_u32_u24 v209, v8, s60, v10
    v_add_u32 v209, 10048, v209
    v_add_u32 v8, 3, v7
    v_lshrrev_b32 v8, 2, v8
    v_mad_u32_u24 v210, v8, s60, v10
    v_add_u32 v210, 20096, v210
    v_and_b32 v8, 32, v1
    v_xor_b32 v209, v209, v8
    v_xor_b32 v210, 32, v210
    s_bitcmp1_b32 0xc888, s53
    s_cselect_b32 s60, 0x40000000, 0
    s_mov_b32 exec_lo, 0
    s_mov_b32 exec_hi, 0xffff
    v_add_u32 v208, s60, v208
    s_mov_b32 exec_lo, 0xffff0000
    s_mov_b32 exec_hi, 0
    v_add_u32 v209, s60, v209
    s_mov_b32 exec_lo, 0xffff
    s_mov_b32 exec_hi, 0xffff0000
    v_add_u32 v210, s60, v210
    s_mov_b64 exec, -1
    s_waitcnt lgkmcnt(0)
    s_mul_i32 s77, s57, 176128
    s_add_u32 m0, s71, 0
    s_add_u32 s77, s77, s56
    buffer_load_dwordx4 v208, s[12:15], s77 offen offset:0 lds
    buffer_load_dwordx4 v209, s[12:15], s77 offen offset:1024 lds
    buffer_load_dwordx4 v210, s[12:15], s77 offen offset:2048 lds
    s_setprio 0
    s_load_dwordx2 s[36:37], s[0:1], 32
    s_mov_b32 s38, 2097152
    s_mov_b32 s39, 0x20000
    s_load_dwordx2 s[16:17], s[0:1], 72
    s_mov_b32 s18, 1409024
    s_mov_b32 s19, 0x20000
    s_load_dwordx2 s[40:41], s[0:1], 88
    s_mov_b32 s42, 2097152
    s_mov_b32 s43, 0x20000
    s_load_dwordx2 s[32:33], s[0:1], 64
    s_mov_b32 s34, 2752
    s_mov_b32 s35, 0x20000
    s_load_dwordx2 s[46:47], s[0:1], 40
    s_load_dwordx2 s[48:49], s[0:1], 80
    v_mov_b32 v172, 0
    v_mov_b32 v173, 0
    v_mov_b32 v174, 0
    v_mov_b32 v175, 0
    v_add_u32 v7, 139264, v3
    ds_write_b128 v7, v[172:175]
    s_lshl_b32 s72, s4, 6
    s_lshl_b32 s60, s5, 1
    s_add_u32 s72, s72, s60
    s_lshl_b32 s64, s72, 1
    s_lshr_b32 s60, s3, 1
    s_add_u32 s72, s72, s60
    s_and_b32 s73, s3, 1
    s_mul_i32 s62, s60, 8320
    s_lshl_b32 s61, s73, 11
    s_add_u32 s62, s62, s61
    s_add_u32 s62, s62, 140320
    s_lshl_b32 s82, s72, 12
    s_add_u32 s63, s82, s61
    v_add_u32 v226, 2, v3
    s_lshl_b32 s60, s2, 2
    s_add_u32 s60, s60, s3
    s_mul_i32 s60, s60, 1408
    v_lshl_add_u32 v186, v1, 7, s60
    s_lshl_b32 s81, s3, 11
    s_lshl_b32 s60, s5, 2
    s_add_u32 s60, s60, s3
    s_mul_i32 s60, s60, 11264
    s_sub_u32 s60, s60, 16000
    s_mov_b64 exec, 0x7ff0000
    v_lshl_add_u32 v186, v1, 10, s60
    s_mov_b64 exec, -1
    s_waitcnt lgkmcnt(0)
    s_load_dword s80, s[46:47], s64
    s_buffer_load_dword s82, s[36:39], s82
    s_buffer_load_dword s79, s[20:23], 0
    s_cmp_lg_u32 s3, 0
    s_cbranch_scc1 C_B1001
    v_lshlrev_b32 v7, 2, v1
    s_lshl_b32 s60, s54, 6
    s_mov_b32 m0, 160064
    s_nop 0
    buffer_load_dword v7, s[32:35], s60 offen lds
C_B1001:
    s_lshl_b32 s61, s7, 7
    s_lshr_b32 s60, s3, 1
    s_lshl_b32 s60, s60, 6
    s_add_u32 s61, s61, s60
    v_and_b32 v224, 48, v3
    v_add_u32 v224, s61, v224
    s_lshl_b32 s77, s57, 7
    s_add_u32 m0, s70, 0
    s_add_u32 s77, s77, s55
    s_add_u32 s57, s57, 1
    s_and_b32 s57, s57, 7
    buffer_load_dwordx4 v204, s[8:11], s77 offen offset:0 lds
    buffer_load_dwordx4 v205, s[8:11], s77 offen offset:1024 lds
    buffer_load_dwordx4 v206, s[8:11], s77 offen offset:2048 lds
    buffer_load_dwordx4 v207, s[8:11], s77 offen offset:3072 lds
    s_mul_i32 s77, s57, 176128
    s_add_u32 m0, s71, 28672
    s_add_u32 s77, s77, s56
    buffer_load_dwordx4 v208, s[12:15], s77 offen offset:0 lds
    buffer_load_dwordx4 v209, s[12:15], s77 offen offset:1024 lds
    s_waitcnt vmcnt(9)
    buffer_load_dwordx4 v210, s[12:15], s77 offen offset:2048 lds
    s_mul_i32 s67, s3, 360448
    s_lshl_b32 s60, s7, 7
    s_add_u32 s67, s67, s60
    s_lshl_b32 s77, s57, 7
    s_add_u32 m0, s70, 28672
    s_add_u32 s77, s77, s55
    s_add_u32 s57, s57, 1
    s_and_b32 s57, s57, 7
    s_waitcnt vmcnt(9)
    buffer_load_dwordx4 v204, s[8:11], s77 offen offset:0 lds
    s_mul_i32 s60, s7, 0
    s_mul_i32 s61, s78, 0
    s_add_u32 s60, s60, s61
    s_cmp_eq_u32 s3, 3
    s_cselect_b32 s61, 8, 9
    s_waitcnt vmcnt(9)
    buffer_load_dwordx4 v205, s[8:11], s77 offen offset:1024 lds
    s_add_u32 s24, s60, 0
    s_and_b32 s24, s24, 3
    s_mul_i32 s24, s24, 3
    s_min_u32 s24, s24, s61
    s_mul_i32 s24, s24, 32768
    s_add_u32 s24, s24, s67
    s_waitcnt vmcnt(9)
    buffer_load_dwordx4 v206, s[8:11], s77 offen offset:2048 lds
    s_add_u32 s25, s60, 1
    s_and_b32 s25, s25, 3
    s_mul_i32 s25, s25, 3
    s_min_u32 s25, s25, s61
    s_mul_i32 s25, s25, 32768
    s_add_u32 s25, s25, s67
    s_waitcnt vmcnt(9)
    buffer_load_dwordx4 v207, s[8:11], s77 offen offset:3072 lds
    s_add_u32 s26, s60, 2
    s_and_b32 s26, s26, 3
    s_mul_i32 s26, s26, 3
    s_min_u32 s26, s26, s61
    s_mul_i32 s26, s26, 32768
    s_add_u32 s26, s26, s67
    s_mul_i32 s77, s57, 176128
    s_add_u32 m0, s71, 57344
    s_add_u32 s77, s77, s56
    s_waitcnt vmcnt(9)
    buffer_load_dwordx4 v208, s[12:15], s77 offen offset:0 lds
    s_add_u32 s27, s60, 3
    s_and_b32 s27, s27, 3
    s_mul_i32 s27, s27, 3
    s_min_u32 s27, s27, s61
    s_mul_i32 s27, s27, 32768
    s_add_u32 s27, s27, s67
    s_waitcnt vmcnt(9)
    buffer_load_dwordx4 v209, s[12:15], s77 offen offset:1024 lds
    v_lshrrev_b32 v7, 5, v1
    v_bfe_u32 v8, v1, 2, 2
    v_lshl_add_u32 v7, v7, 2, v8
    v_and_b32 v8, 48, v3
    v_lshl_or_b32 v5, v7, 10, v8
    s_waitcnt vmcnt(9)
    buffer_load_dwordx4 v210, s[12:15], s77 offen offset:2048 lds
    v_and_b32 v7, 16, v1
    v_lshl_or_b32 v5, v7, 2, v5
    v_add_u32 v6, 15360, v5
    s_waitcnt lgkmcnt(0)
    s_barrier
    s_lshl_b32 s77, s57, 7
    s_add_u32 m0, s70, 57344
    s_add_u32 s77, s77, s55
    s_add_u32 s57, s57, 1
    s_and_b32 s57, s57, 7
    s_waitcnt vmcnt(9)
    buffer_load_dwordx4 v204, s[8:11], s77 offen offset:0 lds
    v_lshrrev_b32 v7, 5, v1
    v_bfe_u32 v8, v1, 2, 3
    v_lshl_or_b32 v225, v7, 4, v8
    s_lshl_b32 s60, s73, 3
    v_add_u32 v225, s60, v225
    s_waitcnt vmcnt(9)
    buffer_load_dwordx4 v205, s[8:11], s77 offen offset:1024 lds
    v_and_b32 v9, 48, v3
    v_lshl_or_b32 v211, v225, 10, v9
    v_lshlrev_b32 v225, 4, v225
    s_waitcnt vmcnt(9)
    buffer_load_dwordx4 v206, s[8:11], s77 offen offset:2048 lds
    s_lshl_b32 s60, s52, 1
    s_add_u32 s60, s60, s6
    s_lshl_b32 s74, s60, 16
    s_lshl_b32 s83, s60, 10
    s_add_u32 s83, s83, 65536
    s_waitcnt vmcnt(9)
    buffer_load_dwordx4 v207, s[8:11], s77 offen offset:3072 lds
    s_lshl_b32 s61, s7, 7
    s_lshr_b32 s60, s3, 1
    s_lshl_b32 s60, s60, 6
    s_add_u32 s61, s61, s60
    s_add_u32 s74, s74, s61
    s_add_u32 s75, s74, 32768
    s_mul_i32 s77, s57, 176128
    s_add_u32 m0, s71, 86016
    s_add_u32 s77, s77, s56
    s_waitcnt vmcnt(9)
    buffer_load_dwordx4 v208, s[12:15], s77 offen offset:0 lds
    v_lshrrev_b32 v7, 3, v1
    v_xor_b32 v7, v7, v1
    v_bfe_u32 v7, v7, 1, 1
    v_and_b32 v8, 1, v1
    v_lshl_or_b32 v7, v8, 1, v7
    v_and_b32 v8, 60, v1
    v_or_b32 v7, v7, v8
    v_lshlrev_b32 v231, 4, v7
    s_waitcnt vmcnt(9)
    buffer_load_dwordx4 v209, s[12:15], s77 offen offset:1024 lds
    v_and_b32 v7, 15, v1
    v_lshrrev_b32 v8, 5, v1
    v_sub_u32 v8, v8, v7
    s_lshl_b32 s60, s73, 3
    s_add_u32 s60, s60, 15
    v_add_u32 v8, s60, v8
    s_waitcnt vmcnt(9)
    buffer_load_dwordx4 v210, s[12:15], s77 offen offset:2048 lds
    s_and_b32 s60, s3, 2
    s_lshl_b32 s60, s60, 4
    v_and_b32 v9, 16, v1
    v_or_b32 v9, s60, v9
    s_barrier
    s_lshl_b32 s77, s57, 7
    s_add_u32 m0, s70, 86016
    s_add_u32 s77, s77, s55
    s_add_u32 s57, s57, 1
    s_and_b32 s57, s57, 7
    s_waitcnt vmcnt(9)
    buffer_load_dwordx4 v204, s[8:11], s77 offen offset:0 lds
    v_lshlrev_b32 v10, 3, v8
    v_and_b32 v10, 32, v10
    v_xor_b32 v10, v10, v9
    v_lshl_add_u32 v10, v8, 6, v10
    v_add_u32 v227, 131072, v10
    s_waitcnt vmcnt(9)
    buffer_load_dwordx4 v205, s[8:11], s77 offen offset:1024 lds
    v_add_u32 v8, 2, v8
    s_waitcnt vmcnt(9)
    buffer_load_dwordx4 v206, s[8:11], s77 offen offset:2048 lds
    v_lshlrev_b32 v10, 3, v8
    v_and_b32 v10, 32, v10
    v_xor_b32 v10, v10, v9
    v_lshl_add_u32 v10, v8, 6, v10
    v_add_u32 v228, 131072, v10
    s_waitcnt vmcnt(9)
    buffer_load_dwordx4 v207, s[8:11], s77 offen offset:3072 lds
    v_add_u32 v8, 2, v8
    s_mul_i32 s77, s57, 176128
    s_add_u32 m0, s71, 0
    s_add_u32 s77, s77, s56
    s_waitcnt vmcnt(9)
    buffer_load_dwordx4 v208, s[12:15], s77 offen offset:0 lds
    v_lshlrev_b32 v10, 3, v8
    v_and_b32 v10, 32, v10
    v_xor_b32 v10, v10, v9
    v_lshl_add_u32 v10, v8, 6, v10
    v_add_u32 v229, 131072, v10
    s_waitcnt vmcnt(9)
    buffer_load_dwordx4 v209, s[12:15], s77 offen offset:1024 lds
    v_add_u32 v8, 2, v8
    s_waitcnt vmcnt(9)
    buffer_load_dwordx4 v210, s[12:15], s77 offen offset:2048 lds
    v_lshlrev_b32 v10, 3, v8
    v_and_b32 v10, 32, v10
    v_xor_b32 v10, v10, v9
    v_lshl_add_u32 v10, v8, 6, v10
    v_add_u32 v230, 131072, v10
    s_barrier
    s_lshl_b32 s77, s57, 7
    s_add_u32 m0, s70, 0
    s_add_u32 s77, s77, s55
    s_add_u32 s57, s57, 1
    s_and_b32 s57, s57, 7
    s_waitcnt vmcnt(9)
    buffer_load_dwordx4 v204, s[8:11], s77 offen offset:0 lds
    s_lshl_b32 s61, s73, 6
    s_sub_u32 s61, 79, s61
    v_sub_u32 v8, s61, v7
    v_lshlrev_b32 v10, 3, v8
    v_and_b32 v10, 32, v10
    v_xor_b32 v10, s60, v10
    v_lshl_add_u32 v10, v8, 6, v10
    s_waitcnt vmcnt(9)
    buffer_load_dwordx4 v205, s[8:11], s77 offen offset:1024 lds
    v_lshrrev_b32 v9, 4, v1
    v_lshlrev_b32 v9, 3, v9
    v_sub_u32 v10, v10, v9
    v_add_u32 v248, 131096, v10
    s_waitcnt vmcnt(9)
    buffer_load_dwordx4 v206, s[8:11], s77 offen offset:2048 lds
    v_add_u32 v7, 1, v7
    v_lshrrev_b32 v8, 1, v7
    v_lshlrev_b32 v8, 2, v8
    v_lshl_add_u32 v8, v9, 1, v8
    v_and_b32 v7, 1, v7
    s_movk_i32 s60, 4160
    v_mad_u32_u24 v7, v7, s60, v8
    s_waitcnt vmcnt(9)
    buffer_load_dwordx4 v207, s[8:11], s77 offen offset:3072 lds
    s_lshr_b32 s60, s3, 1
    s_mul_i32 s60, s60, 8320
    s_lshl_b32 s61, s73, 8
    s_add_u32 s60, s60, s61
    s_add_u32 s60, s60, 140288
    v_add_u32 v11, s60, v7
    s_mul_i32 s77, s57, 176128
    s_add_u32 m0, s71, 28672
    s_add_u32 s77, s77, s56
    s_waitcnt vmcnt(9)
    buffer_load_dwordx4 v208, s[12:15], s77 offen offset:0 lds
    s_lshl_b32 s64, s4, 5
    s_add_u32 s64, s64, s5
    s_lshl_b32 s64, s64, 13
    s_add_u32 s64, s64, s81
    s_add_u32 s64, s64, 2097152
    s_waitcnt vmcnt(9)
    buffer_load_dwordx4 v209, s[12:15], s77 offen offset:1024 lds
    s_mul_i32 s60, s3, 4160
    s_add_u32 s60, s60, 140288
    v_add_u32 v7, s60, v3
    s_waitcnt vmcnt(9)
    buffer_load_dwordx4 v210, s[12:15], s77 offen offset:2048 lds
    s_barrier
    s_lshl_b32 s77, s57, 7
    s_add_u32 m0, s70, 28672
    s_add_u32 s77, s77, s55
    s_add_u32 s57, s57, 1
    s_and_b32 s57, s57, 7
    s_waitcnt vmcnt(9)
    buffer_load_dwordx4 v204, s[8:11], s77 offen offset:0 lds
    s_waitcnt vmcnt(9)
    buffer_load_dwordx4 v205, s[8:11], s77 offen offset:1024 lds
    s_waitcnt vmcnt(9)
    buffer_load_dwordx4 v206, s[8:11], s77 offen offset:2048 lds
    s_waitcnt vmcnt(9)
    buffer_load_dwordx4 v207, s[8:11], s77 offen offset:3072 lds
    s_mul_i32 s77, s57, 176128
    s_add_u32 m0, s71, 57344
    s_add_u32 s77, s77, s56
    s_waitcnt vmcnt(9)
    buffer_load_dwordx4 v208, s[12:15], s77 offen offset:0 lds
    s_waitcnt vmcnt(9)
    buffer_load_dwordx4 v209, s[12:15], s77 offen offset:1024 lds
    s_waitcnt vmcnt(9)
    buffer_load_dwordx4 v210, s[12:15], s77 offen offset:2048 lds
    s_barrier
    s_lshl_b32 s77, s57, 7
    s_add_u32 m0, s70, 57344
    s_add_u32 s77, s77, s55
    s_add_u32 s57, s57, 1
    s_and_b32 s57, s57, 7
    s_waitcnt vmcnt(9)
    buffer_load_dwordx4 v204, s[8:11], s77 offen offset:0 lds
    s_waitcnt vmcnt(9)
    buffer_load_dwordx4 v205, s[8:11], s77 offen offset:1024 lds
    s_waitcnt vmcnt(9)
    buffer_load_dwordx4 v206, s[8:11], s77 offen offset:2048 lds
    s_waitcnt vmcnt(9)
    buffer_load_dwordx4 v207, s[8:11], s77 offen offset:3072 lds
    s_mov_b64 exec, 2047
    s_waitcnt vmcnt(9)
    buffer_load_dword v185, v186, s[16:19], 0 offen
    s_mov_b64 exec, -1
    s_waitcnt vmcnt(9)
    global_load_dwordx4 v[220:223], v224, s[48:49]
    s_mov_b32 m0, s62
    s_waitcnt vmcnt(9)
    buffer_load_dwordx4 v3, s[36:39], s63 offen lds
    s_barrier
    s_waitcnt vmcnt(9)
    buffer_load_dwordx4 v3, s[36:39], s63 offen offset:1024 lds
    s_mul_i32 s77, s57, 176128
    s_add_u32 m0, s71, 86016
    s_add_u32 s77, s77, s56
    s_waitcnt vmcnt(9)
    buffer_load_dwordx4 v208, s[12:15], s77 offen offset:0 lds
    s_waitcnt vmcnt(9)
    buffer_load_dwordx4 v209, s[12:15], s77 offen offset:1024 lds
    s_waitcnt vmcnt(9)
    buffer_load_dwordx4 v210, s[12:15], s77 offen offset:2048 lds
    s_lshl_b32 s77, s57, 7
    s_add_u32 m0, s70, 86016
    s_add_u32 s77, s77, s55
    s_add_u32 s57, s57, 1
    s_and_b32 s57, s57, 7
    s_waitcnt vmcnt(9)
    buffer_load_dwordx4 v204, s[8:11], s77 offen offset:0 lds
    s_waitcnt vmcnt(9)
    buffer_load_dwordx4 v205, s[8:11], s77 offen offset:1024 lds
    s_waitcnt vmcnt(9)
    buffer_load_dwordx4 v206, s[8:11], s77 offen offset:2048 lds
    s_barrier
    s_waitcnt vmcnt(9)
    buffer_load_dwordx4 v207, s[8:11], s77 offen offset:3072 lds
    s_waitcnt vmcnt(9)
    buffer_load_dwordx4 v[212:215], v211, s[8:11], s74 offen
    s_waitcnt vmcnt(9)
    buffer_load_dwordx4 v[216:219], v211, s[8:11], s75 offen
    s_waitcnt vmcnt(9)
    buffer_load_dwordx3 v[188:190], v225, s[20:23], s83 offen sc1
    s_waitcnt vmcnt(9)
    buffer_load_dwordx3 v[192:194], v225, s[20:23], s83 offen offset:512 sc1
    s_mov_b64 exec, 0x7ff0000
    s_waitcnt vmcnt(9)
    buffer_load_dword v185, v186, s[16:19], 0 offen
    s_mov_b64 exec, -1
    s_add_u32 m0, s81, 131072
    s_waitcnt vmcnt(9)
    buffer_load_dwordx4 v231, s[20:23], s64 offen sc1 lds
    s_waitcnt vmcnt(9)
    buffer_load_dwordx4 v231, s[20:23], s64 offen offset:1024 sc1 lds
    s_add_u32 m0, s62, 4160
    s_waitcnt vmcnt(9)
    buffer_load_dwordx4 v226, s[36:39], s63 offen lds
    s_waitcnt vmcnt(9)
    buffer_load_dwordx4 v226, s[36:39], s63 offen offset:1024 lds
    s_add_u32 m0, s81, 0
    s_add_u32 s55, s24, 0
    s_waitcnt vmcnt(9)
    buffer_load_dwordx4 v5, s[16:19], s55 offen lds
    s_barrier
    s_lshl_b32 s82, s82, 16
    s_mul_i32 s82, s82, s73
    v_writelane_b32 v175, s82, 1
    s_mov_b64 exec, 3
    ds_write_b128 v7, v[172:175]
    s_mov_b64 exec, -1
    s_lshr_b32 s60, s3, 1
    s_xor_b32 s60, s60, 1
    s_lshl_b32 s60, s60, 4
    s_lshl_b32 s80, s80, s60
    s_and_b32 s80, s80, 0xffff0000
    s_add_u32 s79, s79, 2654435761
    v_mov_b32 v4, s79
    s_waitcnt lgkmcnt(0)
    s_barrier
    v_add_u32 v204, 1024, v11
    v_add_u32 v205, 2048, v11
    v_add_u32 v206, 3072, v11
    s_waitcnt vmcnt(6)
    buffer_load_dwordx4 v6, s[16:19], s55 offen offset:1024 lds
    s_add_u32 m0, s81, 8192
    s_add_u32 s55, s24, 8192
    s_waitcnt vmcnt(6)
    buffer_load_dwordx4 v5, s[16:19], s55 offen lds
    s_waitcnt vmcnt(6)
    buffer_load_dwordx4 v6, s[16:19], s55 offen offset:1024 lds
    s_add_u32 m0, s81, 16384
    s_add_u32 s55, s25, 0
    s_waitcnt vmcnt(6)
    buffer_load_dwordx4 v5, s[16:19], s55 offen lds
    s_waitcnt vmcnt(6)
    buffer_load_dwordx4 v6, s[16:19], s55 offen offset:1024 lds
    s_add_u32 m0, s81, 24576
    s_add_u32 s55, s25, 8192
    s_waitcnt vmcnt(6)
    buffer_load_dwordx4 v5, s[16:19], s55 offen lds
    s_waitcnt vmcnt(6)
    buffer_load_dwordx4 v6, s[16:19], s55 offen offset:1024 lds
    s_add_u32 m0, s81, 32768
    s_add_u32 s55, s26, 0
    s_waitcnt vmcnt(6)
    buffer_load_dwordx4 v5, s[16:19], s55 offen lds
    s_waitcnt vmcnt(6)
    buffer_load_dwordx4 v6, s[16:19], s55 offen offset:1024 lds
    v_mov_b32 v250, v188
    v_add_f32 v251, 0x3727c5ac, v190
    v_rsq_f32 v251, v251
    v_mov_b32 v252, v192
    v_add_f32 v253, 0x3727c5ac, v194
    v_rsq_f32 v253, v253
    s_barrier
    s_add_u32 m0, s81, 40960
    s_add_u32 s55, s26, 8192
    s_waitcnt vmcnt(6)
    buffer_load_dwordx4 v5, s[16:19], s55 offen lds
    ds_read2_b32 v[12:13], v11 offset0:0 offset1:1
    ds_read2_b32 v[14:15], v11 offset0:2 offset1:3
    ds_read2_b32 v[28:29], v11 offset0:128 offset1:129
    ds_read2_b32 v[30:31], v11 offset0:130 offset1:131
    s_waitcnt vmcnt(6)
    buffer_load_dwordx4 v6, s[16:19], s55 offen offset:1024 lds
    ds_read2_b32 v[44:45], v204 offset0:0 offset1:1
    ds_read2_b32 v[46:47], v204 offset0:2 offset1:3
    ds_read2_b32 v[60:61], v204 offset0:128 offset1:129
    ds_read2_b32 v[62:63], v204 offset0:130 offset1:131
    s_add_u32 m0, s81, 49152
    s_add_u32 s55, s27, 0
    s_waitcnt vmcnt(6)
    buffer_load_dwordx4 v5, s[16:19], s55 offen lds
    ds_read2_b32 v[76:77], v205 offset0:0 offset1:1
    ds_read2_b32 v[78:79], v205 offset0:2 offset1:3
    ds_read2_b32 v[92:93], v205 offset0:128 offset1:129
    ds_read2_b32 v[94:95], v205 offset0:130 offset1:131
    s_waitcnt vmcnt(6)
    buffer_load_dwordx4 v6, s[16:19], s55 offen offset:1024 lds
    ds_read2_b32 v[108:109], v206 offset0:0 offset1:1
    ds_read2_b32 v[110:111], v206 offset0:2 offset1:3
    ds_read2_b32 v[124:125], v206 offset0:128 offset1:129
    ds_read2_b32 v[126:127], v206 offset0:130 offset1:131
    ds_read_b128 v[140:143], v227 offset:7168
    ds_read_b128 v[144:147], v227 offset:6144
    ds_read_b128 v[148:151], v227 offset:5120
    ds_read_b128 v[152:155], v227 offset:4096
    ds_read_b128 v[156:159], v227 offset:3072
    ds_read_b128 v[160:163], v227 offset:2048
    ds_read_b128 v[164:167], v227 offset:1024
    ds_read_b128 v[168:171], v227 offset:0
    ds_read_b64 v[234:235], v248 offset:3072
    ds_read_b64 v[238:239], v248 offset:2048
    ds_read_b64 v[242:243], v248 offset:1024
    ds_read_b64 v[246:247], v248 offset:0
    s_setprio 0
    s_waitcnt lgkmcnt(0)
    s_barrier
    v_mfma_f32_16x16x32_bf16 v[172:175], v[12:15], v[140:143], 0
    v_and_b32 v232, 0xffff0000, v235
    v_mfma_f32_16x16x32_bf16 v[176:179], v[28:31], v[140:143], 0
    ds_read2_b32 v[16:17], v11 offset0:16 offset1:17
    v_mfma_f32_16x16x32_bf16 v[180:183], v[44:47], v[140:143], 0
    v_lshlrev_b32 v233, 16, v235
    v_mfma_f32_16x16x32_bf16 v[184:187], v[60:63], v[140:143], 0
    ds_read2_b32 v[18:19], v11 offset0:18 offset1:19
    v_mfma_f32_16x16x32_bf16 v[188:191], v[76:79], v[140:143], 0
    v_lshlrev_b32 v235, 16, v234
    v_mfma_f32_16x16x32_bf16 v[192:195], v[92:95], v[140:143], 0
    ds_read2_b32 v[32:33], v11 offset0:144 offset1:145
    v_mfma_f32_16x16x32_bf16 v[196:199], v[108:111], v[140:143], 0
    v_and_b32 v234, 0xffff0000, v234
    v_mfma_f32_16x16x32_bf16 v[200:203], v[124:127], v[140:143], 0
    ds_read2_b32 v[34:35], v11 offset0:146 offset1:147
    ds_read_b128 v[140:143], v228 offset:7168
    v_mfma_f32_16x16x32_bf16 v[176:179], v[12:15], v[144:147], v[176:179]
    v_mul_f32 v232, s80, v232
    v_mfma_f32_16x16x32_bf16 v[180:183], v[28:31], v[144:147], v[180:183]
    ds_read2_b32 v[48:49], v204 offset0:16 offset1:17
    v_mfma_f32_16x16x32_bf16 v[184:187], v[44:47], v[144:147], v[184:187]
    v_mul_f32 v233, s80, v233
    v_mfma_f32_16x16x32_bf16 v[188:191], v[60:63], v[144:147], v[188:191]
    ds_read2_b32 v[50:51], v204 offset0:18 offset1:19
    v_mfma_f32_16x16x32_bf16 v[192:195], v[76:79], v[144:147], v[192:195]
    v_mul_f32 v234, s80, v234
    v_mfma_f32_16x16x32_bf16 v[196:199], v[92:95], v[144:147], v[196:199]
    ds_read2_b32 v[64:65], v204 offset0:144 offset1:145
    v_mfma_f32_16x16x32_bf16 v[200:203], v[108:111], v[144:147], v[200:203]
    v_mul_f32 v235, s80, v235
    ds_read_b128 v[144:147], v228 offset:6144
    v_mfma_f32_16x16x32_bf16 v[180:183], v[12:15], v[148:151], v[180:183]
    ds_read2_b32 v[66:67], v204 offset0:146 offset1:147
    v_mfma_f32_16x16x32_bf16 v[184:187], v[28:31], v[148:151], v[184:187]
    v_and_b32 v236, 0xffff0000, v239
    v_mfma_f32_16x16x32_bf16 v[188:191], v[44:47], v[148:151], v[188:191]
    ds_read2_b32 v[80:81], v205 offset0:16 offset1:17
    v_mfma_f32_16x16x32_bf16 v[192:195], v[60:63], v[148:151], v[192:195]
    v_lshlrev_b32 v237, 16, v239
    v_mfma_f32_16x16x32_bf16 v[196:199], v[76:79], v[148:151], v[196:199]
    ds_read2_b32 v[82:83], v205 offset0:18 offset1:19
    v_mfma_f32_16x16x32_bf16 v[200:203], v[92:95], v[148:151], v[200:203]
    v_lshlrev_b32 v239, 16, v238
    ds_read_b128 v[148:151], v228 offset:5120
    v_mfma_f32_16x16x32_bf16 v[184:187], v[12:15], v[152:155], v[184:187]
    ds_read2_b32 v[96:97], v205 offset0:144 offset1:145
    v_mfma_f32_16x16x32_bf16 v[188:191], v[28:31], v[152:155], v[188:191]
    v_and_b32 v238, 0xffff0000, v238
    v_mfma_f32_16x16x32_bf16 v[192:195], v[44:47], v[152:155], v[192:195]
    ds_read2_b32 v[98:99], v205 offset0:146 offset1:147
    v_mfma_f32_16x16x32_bf16 v[196:199], v[60:63], v[152:155], v[196:199]
    v_mul_f32 v236, s80, v236
    v_mfma_f32_16x16x32_bf16 v[200:203], v[76:79], v[152:155], v[200:203]
    ds_read2_b32 v[112:113], v206 offset0:16 offset1:17
    ds_read_b128 v[152:155], v228 offset:4096
    v_mfma_f32_16x16x32_bf16 v[188:191], v[12:15], v[156:159], v[188:191]
    v_mul_f32 v237, s80, v237
    v_mfma_f32_16x16x32_bf16 v[192:195], v[28:31], v[156:159], v[192:195]
    ds_read2_b32 v[114:115], v206 offset0:18 offset1:19
    v_mfma_f32_16x16x32_bf16 v[196:199], v[44:47], v[156:159], v[196:199]
    v_mul_f32 v238, s80, v238
    v_mfma_f32_16x16x32_bf16 v[200:203], v[60:63], v[156:159], v[200:203]
    ds_read2_b32 v[128:129], v206 offset0:144 offset1:145
    ds_read_b128 v[156:159], v228 offset:3072
    v_mfma_f32_16x16x32_bf16 v[192:195], v[12:15], v[160:163], v[192:195]
    v_mul_f32 v239, s80, v239
    v_mfma_f32_16x16x32_bf16 v[196:199], v[28:31], v[160:163], v[196:199]
    ds_read2_b32 v[130:131], v206 offset0:146 offset1:147
    v_mfma_f32_16x16x32_bf16 v[200:203], v[44:47], v[160:163], v[200:203]
    v_and_b32 v240, 0xffff0000, v243
    ds_read_b128 v[160:163], v228 offset:2048
    v_mfma_f32_16x16x32_bf16 v[196:199], v[12:15], v[164:167], v[196:199]
    ds_read2_b32 v[20:21], v11 offset0:32 offset1:33
    v_mfma_f32_16x16x32_bf16 v[200:203], v[28:31], v[164:167], v[200:203]
    v_lshlrev_b32 v241, 16, v243
    ds_read_b128 v[164:167], v228 offset:1024
    v_mfma_f32_16x16x32_bf16 v[200:203], v[12:15], v[168:171], v[200:203]
    ds_read2_b32 v[22:23], v11 offset0:34 offset1:35
    ds_read_b128 v[168:171], v228 offset:0
    s_waitcnt lgkmcnt(15)
    v_mfma_f32_16x16x32_bf16 v[172:175], v[16:19], v[140:143], v[172:175]
    v_lshlrev_b32 v243, 16, v242
    v_mfma_f32_16x16x32_bf16 v[176:179], v[32:35], v[140:143], v[176:179]
    ds_read2_b32 v[36:37], v11 offset0:160 offset1:161
    v_mfma_f32_16x16x32_bf16 v[180:183], v[48:51], v[140:143], v[180:183]
    v_and_b32 v242, 0xffff0000, v242
    v_mfma_f32_16x16x32_bf16 v[184:187], v[64:67], v[140:143], v[184:187]
    ds_read2_b32 v[38:39], v11 offset0:162 offset1:163
    s_waitcnt lgkmcnt(15)
    v_mfma_f32_16x16x32_bf16 v[188:191], v[80:83], v[140:143], v[188:191]
    v_mul_f32 v240, s80, v240
    s_waitcnt lgkmcnt(13)
    v_mfma_f32_16x16x32_bf16 v[192:195], v[96:99], v[140:143], v[192:195]
    ds_read2_b32 v[52:53], v204 offset0:32 offset1:33
    s_waitcnt lgkmcnt(11)
    v_mfma_f32_16x16x32_bf16 v[196:199], v[112:115], v[140:143], v[196:199]
    v_mul_f32 v241, s80, v241
    s_waitcnt lgkmcnt(8)
    v_mfma_f32_16x16x32_bf16 v[200:203], v[128:131], v[140:143], v[200:203]
    ds_read2_b32 v[54:55], v204 offset0:34 offset1:35
    ds_read_b128 v[140:143], v229 offset:7168
    v_mfma_f32_16x16x32_bf16 v[176:179], v[16:19], v[144:147], v[176:179]
    v_mul_f32 v242, s80, v242
    v_mfma_f32_16x16x32_bf16 v[180:183], v[32:35], v[144:147], v[180:183]
    ds_read2_b32 v[68:69], v204 offset0:160 offset1:161
    v_mfma_f32_16x16x32_bf16 v[184:187], v[48:51], v[144:147], v[184:187]
    v_mul_f32 v243, s80, v243
    v_mfma_f32_16x16x32_bf16 v[188:191], v[64:67], v[144:147], v[188:191]
    ds_read2_b32 v[70:71], v204 offset0:162 offset1:163
    v_mfma_f32_16x16x32_bf16 v[192:195], v[80:83], v[144:147], v[192:195]
    v_and_b32 v244, 0xffff0000, v247
    v_mfma_f32_16x16x32_bf16 v[196:199], v[96:99], v[144:147], v[196:199]
    ds_read2_b32 v[84:85], v205 offset0:32 offset1:33
    v_mfma_f32_16x16x32_bf16 v[200:203], v[112:115], v[144:147], v[200:203]
    v_lshlrev_b32 v245, 16, v247
    ds_read_b128 v[144:147], v229 offset:6144
    v_mfma_f32_16x16x32_bf16 v[180:183], v[16:19], v[148:151], v[180:183]
    ds_read2_b32 v[86:87], v205 offset0:34 offset1:35
    v_mfma_f32_16x16x32_bf16 v[184:187], v[32:35], v[148:151], v[184:187]
    v_lshlrev_b32 v247, 16, v246
    v_mfma_f32_16x16x32_bf16 v[188:191], v[48:51], v[148:151], v[188:191]
    ds_read2_b32 v[100:101], v205 offset0:160 offset1:161
    v_mfma_f32_16x16x32_bf16 v[192:195], v[64:67], v[148:151], v[192:195]
    v_and_b32 v246, 0xffff0000, v246
    v_mfma_f32_16x16x32_bf16 v[196:199], v[80:83], v[148:151], v[196:199]
    ds_read2_b32 v[102:103], v205 offset0:162 offset1:163
    v_mfma_f32_16x16x32_bf16 v[200:203], v[96:99], v[148:151], v[200:203]
    v_mul_f32 v244, s80, v244
    ds_read_b128 v[148:151], v229 offset:5120
    v_mfma_f32_16x16x32_bf16 v[184:187], v[16:19], v[152:155], v[184:187]
    ds_read2_b32 v[116:117], v206 offset0:32 offset1:33
    v_mfma_f32_16x16x32_bf16 v[188:191], v[32:35], v[152:155], v[188:191]
    v_mul_f32 v245, s80, v245
    v_mfma_f32_16x16x32_bf16 v[192:195], v[48:51], v[152:155], v[192:195]
    ds_read2_b32 v[118:119], v206 offset0:34 offset1:35
    v_mfma_f32_16x16x32_bf16 v[196:199], v[64:67], v[152:155], v[196:199]
    v_mul_f32 v246, s80, v246
    v_mfma_f32_16x16x32_bf16 v[200:203], v[80:83], v[152:155], v[200:203]
    ds_read2_b32 v[132:133], v206 offset0:160 offset1:161
    ds_read_b128 v[152:155], v229 offset:4096
    v_mfma_f32_16x16x32_bf16 v[188:191], v[16:19], v[156:159], v[188:191]
    v_mul_f32 v247, s80, v247
    v_mfma_f32_16x16x32_bf16 v[192:195], v[32:35], v[156:159], v[192:195]
    ds_read2_b32 v[134:135], v206 offset0:162 offset1:163
    v_mfma_f32_16x16x32_bf16 v[196:199], v[48:51], v[156:159], v[196:199]
    s_lshl_b32 s60, s3, 12
    v_mfma_f32_16x16x32_bf16 v[200:203], v[64:67], v[156:159], v[200:203]
    ds_read2_b32 v[24:25], v11 offset0:48 offset1:49
    ds_read_b128 v[156:159], v229 offset:3072
    s_waitcnt lgkmcnt(15)
    v_mfma_f32_16x16x32_bf16 v[192:195], v[16:19], v[160:163], v[192:195]
    s_add_u32 s60, s60, 114688
    v_mfma_f32_16x16x32_bf16 v[196:199], v[32:35], v[160:163], v[196:199]
    ds_read2_b32 v[26:27], v11 offset0:50 offset1:51
    v_mfma_f32_16x16x32_bf16 v[200:203], v[48:51], v[160:163], v[200:203]
    v_add_u32 v7, s60, v3
    ds_read_b128 v[160:163], v229 offset:2048
    v_mfma_f32_16x16x32_bf16 v[196:199], v[16:19], v[164:167], v[196:199]
    ds_read2_b32 v[40:41], v11 offset0:176 offset1:177
    v_mfma_f32_16x16x32_bf16 v[200:203], v[32:35], v[164:167], v[200:203]
    s_xor_b32 s61, s3, 1
    ds_read_b128 v[164:167], v229 offset:1024
    v_mfma_f32_16x16x32_bf16 v[200:203], v[16:19], v[168:171], v[200:203]
    ds_read2_b32 v[42:43], v11 offset0:178 offset1:179
    ds_read_b128 v[168:171], v229 offset:0
    v_mfma_f32_16x16x32_bf16 v[172:175], v[20:23], v[140:143], v[172:175]
    s_lshl_b32 s62, s61, 12
    v_mfma_f32_16x16x32_bf16 v[176:179], v[36:39], v[140:143], v[176:179]
    ds_read2_b32 v[56:57], v204 offset0:48 offset1:49
    v_mfma_f32_16x16x32_bf16 v[180:183], v[52:55], v[140:143], v[180:183]
    s_add_u32 s62, s62, 114688
    s_waitcnt lgkmcnt(15)
    v_mfma_f32_16x16x32_bf16 v[184:187], v[68:71], v[140:143], v[184:187]
    ds_read2_b32 v[58:59], v204 offset0:50 offset1:51
    v_mfma_f32_16x16x32_bf16 v[188:191], v[84:87], v[140:143], v[188:191]
    v_add_u32 v8, s62, v3
    v_mfma_f32_16x16x32_bf16 v[192:195], v[100:103], v[140:143], v[192:195]
    ds_read2_b32 v[72:73], v204 offset0:176 offset1:177
    s_waitcnt lgkmcnt(14)
    v_mfma_f32_16x16x32_bf16 v[196:199], v[116:119], v[140:143], v[196:199]
    v_bfe_u32 v231, v1, 2, 3
    s_waitcnt lgkmcnt(11)
    v_mfma_f32_16x16x32_bf16 v[200:203], v[132:135], v[140:143], v[200:203]
    ds_read2_b32 v[74:75], v204 offset0:178 offset1:179
    ds_read_b128 v[140:143], v230 offset:7168
    v_mfma_f32_16x16x32_bf16 v[176:179], v[20:23], v[144:147], v[176:179]
    v_lshlrev_b32 v231, 16, v231
    v_mfma_f32_16x16x32_bf16 v[180:183], v[36:39], v[144:147], v[180:183]
    ds_read2_b32 v[88:89], v205 offset0:48 offset1:49
    v_mfma_f32_16x16x32_bf16 v[184:187], v[52:55], v[144:147], v[184:187]
    v_lshrrev_b32 v248, 5, v1
    v_mfma_f32_16x16x32_bf16 v[188:191], v[68:71], v[144:147], v[188:191]
    ds_read2_b32 v[90:91], v205 offset0:50 offset1:51
    v_mfma_f32_16x16x32_bf16 v[192:195], v[84:87], v[144:147], v[192:195]
    v_lshl_or_b32 v231, v248, 11, v231
    v_mfma_f32_16x16x32_bf16 v[196:199], v[100:103], v[144:147], v[196:199]
    ds_read2_b32 v[104:105], v205 offset0:176 offset1:177
    v_mfma_f32_16x16x32_bf16 v[200:203], v[116:119], v[144:147], v[200:203]
    v_and_b32 v248, 48, v3
    ds_read_b128 v[144:147], v230 offset:6144
    v_mfma_f32_16x16x32_bf16 v[180:183], v[20:23], v[148:151], v[180:183]
    ds_read2_b32 v[106:107], v205 offset0:178 offset1:179
    v_mfma_f32_16x16x32_bf16 v[184:187], v[36:39], v[148:151], v[184:187]
    v_or_b32 v231, v231, v248
    v_mfma_f32_16x16x32_bf16 v[188:191], v[52:55], v[148:151], v[188:191]
    ds_read2_b32 v[120:121], v206 offset0:48 offset1:49
    v_mfma_f32_16x16x32_bf16 v[192:195], v[68:71], v[148:151], v[192:195]
    s_lshl_b32 s64, s73, 20
    v_mfma_f32_16x16x32_bf16 v[196:199], v[84:87], v[148:151], v[196:199]
    ds_read2_b32 v[122:123], v206 offset0:50 offset1:51
    v_mfma_f32_16x16x32_bf16 v[200:203], v[100:103], v[148:151], v[200:203]
    s_lshl_b32 s61, s4, 13
    ds_read_b128 v[148:151], v230 offset:5120
    v_mfma_f32_16x16x32_bf16 v[184:187], v[20:23], v[152:155], v[184:187]
    ds_read2_b32 v[136:137], v206 offset0:176 offset1:177
    v_mfma_f32_16x16x32_bf16 v[188:191], v[36:39], v[152:155], v[188:191]
    s_add_u32 s64, s64, s61
    v_mfma_f32_16x16x32_bf16 v[192:195], v[52:55], v[152:155], v[192:195]
    ds_read2_b32 v[138:139], v206 offset0:178 offset1:179
    v_mfma_f32_16x16x32_bf16 v[196:199], v[68:71], v[152:155], v[196:199]
    s_lshr_b32 s61, s5, 4
    v_mfma_f32_16x16x32_bf16 v[200:203], v[84:87], v[152:155], v[200:203]
    s_lshl_b32 s61, s61, 12
    ds_read_b128 v[152:155], v230 offset:4096
    s_waitcnt lgkmcnt(15)
    v_mfma_f32_16x16x32_bf16 v[188:191], v[20:23], v[156:159], v[188:191]
    s_add_u32 s64, s64, s61
    v_mfma_f32_16x16x32_bf16 v[192:195], v[36:39], v[156:159], v[192:195]
    s_and_b32 s61, s72, 31
    v_mfma_f32_16x16x32_bf16 v[196:199], v[52:55], v[156:159], v[196:199]
    s_lshl_b32 s61, s61, 6
    v_mfma_f32_16x16x32_bf16 v[200:203], v[68:71], v[156:159], v[200:203]
    s_add_u32 s64, s64, s61
    ds_read_b128 v[156:159], v230 offset:3072
    v_mfma_f32_16x16x32_bf16 v[192:195], v[20:23], v[160:163], v[192:195]
    s_add_u32 s64, s64, 4194304
    v_mfma_f32_16x16x32_bf16 v[196:199], v[36:39], v[160:163], v[196:199]
    s_add_u32 s77, s64, 524288
    v_mfma_f32_16x16x32_bf16 v[200:203], v[52:55], v[160:163], v[200:203]
    s_mov_b32 s62, 0x00010001
    ds_read_b128 v[160:163], v230 offset:2048
    v_mfma_f32_16x16x32_bf16 v[196:199], v[20:23], v[164:167], v[196:199]
    s_mov_b32 s63, 0x07060302
    v_mfma_f32_16x16x32_bf16 v[200:203], v[36:39], v[164:167], v[200:203]
    v_lshrrev_b32 v248, 1, v248
    ds_read_b128 v[164:167], v230 offset:1024
    v_mfma_f32_16x16x32_bf16 v[200:203], v[20:23], v[168:171], v[200:203]
    v_lshrrev_b32 v248, v248, v4
    ds_read_b128 v[168:171], v230 offset:0
    s_waitcnt lgkmcnt(15)
    v_mfma_f32_16x16x32_bf16 v[172:175], v[24:27], v[140:143], v[172:175]
    v_and_b32 v248, 0xff, v248
    v_mfma_f32_16x16x32_bf16 v[176:179], v[40:43], v[140:143], v[176:179]
    v_lshl_or_b32 v224, v248, 15, v248
    v_mfma_f32_16x16x32_bf16 v[180:183], v[56:59], v[140:143], v[180:183]
    v_lshrrev_b32 v225, 2, v224
    v_mfma_f32_16x16x32_bf16 v[184:187], v[72:75], v[140:143], v[184:187]
    v_lshrrev_b32 v226, 4, v224
    s_waitcnt lgkmcnt(13)
    v_mfma_f32_16x16x32_bf16 v[188:191], v[88:91], v[140:143], v[188:191]
    v_lshrrev_b32 v249, 6, v224
    s_waitcnt lgkmcnt(10)
    v_mfma_f32_16x16x32_bf16 v[192:195], v[104:107], v[140:143], v[192:195]
    s_waitcnt lgkmcnt(8)
    v_mfma_f32_16x16x32_bf16 v[196:199], v[120:123], v[140:143], v[196:199]
    s_waitcnt lgkmcnt(5)
    v_mfma_f32_16x16x32_bf16 v[200:203], v[136:139], v[140:143], v[200:203]
    v_mfma_f32_16x16x32_bf16 v[176:179], v[24:27], v[144:147], v[176:179]
    v_mfma_f32_16x16x32_bf16 v[180:183], v[40:43], v[144:147], v[180:183]
    v_mfma_f32_16x16x32_bf16 v[184:187], v[56:59], v[144:147], v[184:187]
    v_mfma_f32_16x16x32_bf16 v[188:191], v[72:75], v[144:147], v[188:191]
    v_mfma_f32_16x16x32_bf16 v[192:195], v[88:91], v[144:147], v[192:195]
    v_mfma_f32_16x16x32_bf16 v[196:199], v[104:107], v[144:147], v[196:199]
    v_mfma_f32_16x16x32_bf16 v[200:203], v[120:123], v[144:147], v[200:203]
    v_mfma_f32_16x16x32_bf16 v[180:183], v[24:27], v[148:151], v[180:183]
    v_mfma_f32_16x16x32_bf16 v[184:187], v[40:43], v[148:151], v[184:187]
    v_mfma_f32_16x16x32_bf16 v[188:191], v[56:59], v[148:151], v[188:191]
    v_mfma_f32_16x16x32_bf16 v[192:195], v[72:75], v[148:151], v[192:195]
    v_mfma_f32_16x16x32_bf16 v[196:199], v[88:91], v[148:151], v[196:199]
    v_mfma_f32_16x16x32_bf16 v[200:203], v[104:107], v[148:151], v[200:203]
    s_waitcnt lgkmcnt(4)
    v_mfma_f32_16x16x32_bf16 v[184:187], v[24:27], v[152:155], v[184:187]
    v_mfma_f32_16x16x32_bf16 v[188:191], v[40:43], v[152:155], v[188:191]
    v_mfma_f32_16x16x32_bf16 v[192:195], v[56:59], v[152:155], v[192:195]
    v_mfma_f32_16x16x32_bf16 v[196:199], v[72:75], v[152:155], v[196:199]
    v_mfma_f32_16x16x32_bf16 v[200:203], v[88:91], v[152:155], v[200:203]
    s_waitcnt lgkmcnt(3)
    v_mfma_f32_16x16x32_bf16 v[188:191], v[24:27], v[156:159], v[188:191]
    v_mfma_f32_16x16x32_bf16 v[192:195], v[40:43], v[156:159], v[192:195]
    v_mfma_f32_16x16x32_bf16 v[196:199], v[56:59], v[156:159], v[196:199]
    v_mfma_f32_16x16x32_bf16 v[200:203], v[72:75], v[156:159], v[200:203]
    s_waitcnt lgkmcnt(2)
    v_mfma_f32_16x16x32_bf16 v[192:195], v[24:27], v[160:163], v[192:195]
    v_mfma_f32_16x16x32_bf16 v[196:199], v[40:43], v[160:163], v[196:199]
    v_mfma_f32_16x16x32_bf16 v[200:203], v[56:59], v[160:163], v[200:203]
    s_waitcnt lgkmcnt(1)
    v_mfma_f32_16x16x32_bf16 v[196:199], v[24:27], v[164:167], v[196:199]
    v_mfma_f32_16x16x32_bf16 v[200:203], v[40:43], v[164:167], v[200:203]
    s_waitcnt lgkmcnt(0)
    v_mfma_f32_16x16x32_bf16 v[200:203], v[24:27], v[168:171], v[200:203]
    s_setprio 3
    s_cmp_eq_u32 s73, 0
    s_nop 5
    s_cbranch_scc1 C_H0
    ds_write_b128 v7, v[172:175] offset:0
    ds_write_b128 v7, v[176:179] offset:1024
    ds_write_b128 v7, v[180:183] offset:2048
    ds_write_b128 v7, v[184:187] offset:3072
    v_add_f32 v232, v232, v188
    v_add_f32 v233, v233, v189
    v_add_f32 v234, v234, v190
    v_add_f32 v235, v235, v191
    v_add_f32 v236, v236, v192
    v_add_f32 v237, v237, v193
    v_add_f32 v238, v238, v194
    v_add_f32 v239, v239, v195
    v_add_f32 v240, v240, v196
    v_add_f32 v241, v241, v197
    v_add_f32 v242, v242, v198
    v_add_f32 v243, v243, v199
    v_add_f32 v244, v244, v200
    v_add_f32 v245, v245, v201
    v_add_f32 v246, v246, v202
    v_add_f32 v247, v247, v203
    s_branch C_H1
C_H0:
    ds_write_b128 v7, v[188:191] offset:0
    ds_write_b128 v7, v[192:195] offset:1024
    ds_write_b128 v7, v[196:199] offset:2048
    ds_write_b128 v7, v[200:203] offset:3072
    v_add_f32 v232, v232, v172
    v_add_f32 v233, v233, v173
    v_add_f32 v234, v234, v174
    v_add_f32 v235, v235, v175
    v_add_f32 v236, v236, v176
    v_add_f32 v237, v237, v177
    v_add_f32 v238, v238, v178
    v_add_f32 v239, v239, v179
    v_add_f32 v240, v240, v180
    v_add_f32 v241, v241, v181
    v_add_f32 v242, v242, v182
    v_add_f32 v243, v243, v183
    v_add_f32 v244, v244, v184
    v_add_f32 v245, v245, v185
    v_add_f32 v246, v246, v186
    v_add_f32 v247, v247, v187
C_H1:
    s_waitcnt vmcnt(0)
    s_waitcnt lgkmcnt(0)
    s_barrier
    ds_read_b128 v[172:175], v8 offset:0
    ds_read_b128 v[176:179], v8 offset:1024
    ds_read_b128 v[180:183], v8 offset:2048
    ds_read_b128 v[184:187], v8 offset:3072
    s_waitcnt lgkmcnt(3)
    v_add_f32 v232, v232, v172
    v_add_f32 v233, v233, v173
    v_add_f32 v234, v234, v174
    v_add_f32 v235, v235, v175
    s_waitcnt lgkmcnt(2)
    v_add_f32 v236, v236, v176
    v_add_f32 v237, v237, v177
    v_add_f32 v238, v238, v178
    v_add_f32 v239, v239, v179
    v_perm_b32 v144, v233, v232, s63
    v_perm_b32 v145, v235, v234, s63
    v_perm_b32 v146, v237, v236, s63
    v_perm_b32 v147, v239, v238, s63
    s_nop 0
    v_permlane16_swap_b32 v144, v146
    v_permlane16_swap_b32 v145, v147
    v_bfi_b32 v144, s62, v224, v144
    v_bfi_b32 v145, s62, v225, v145
    v_bfi_b32 v146, s62, v226, v146
    v_bfi_b32 v147, s62, v249, v147
    buffer_store_dwordx4 v[144:147], v231, s[20:23], s64 offen sc1
    s_waitcnt lgkmcnt(1)
    v_add_f32 v240, v240, v180
    v_add_f32 v241, v241, v181
    v_add_f32 v242, v242, v182
    v_add_f32 v243, v243, v183
    s_waitcnt lgkmcnt(0)
    v_add_f32 v244, v244, v184
    v_add_f32 v245, v245, v185
    v_add_f32 v246, v246, v186
    v_add_f32 v247, v247, v187
    v_perm_b32 v148, v241, v240, s63
    v_perm_b32 v149, v243, v242, s63
    v_perm_b32 v150, v245, v244, s63
    v_perm_b32 v151, v247, v246, s63
    s_nop 0
    v_permlane16_swap_b32 v148, v150
    v_permlane16_swap_b32 v149, v151
    v_bfi_b32 v148, s62, v224, v148
    v_bfi_b32 v149, s62, v225, v149
    v_bfi_b32 v150, s62, v226, v150
    v_bfi_b32 v151, s62, v249, v151
    buffer_store_dwordx4 v[148:151], v231, s[20:23], s77 offen sc1
    s_setprio 0
    s_xor_b32 s63, s2, 226
    s_or_b32 s63, s63, s3
    s_cmp_lg_u32 s63, 0
    s_cbranch_scc1 C_E0
    s_mov_b32 s65, 0
    s_mov_b32 s62, 262144
    v_lshrrev_b32 v76, 1, v1
    v_and_b32 v77, 1, v1
    v_lshlrev_b32 v76, 16, v76
    v_mul_i32_i24 v77, 2048, v77
    v_add_u32 v77, v77, v76
    s_mov_b64 exec, 0xff
    buffer_load_dword v76, v77, s[20:23], s62 offen sc1
    s_mov_b64 exec, -1
C_E0:
    v_lshlrev_b32 v64, 16, v220
    v_and_b32 v65, 0xffff0000, v220
    v_lshlrev_b32 v66, 16, v221
    v_and_b32 v67, 0xffff0000, v221
    v_lshlrev_b32 v68, 16, v222
    v_and_b32 v69, 0xffff0000, v222
    v_lshlrev_b32 v70, 16, v223
    v_and_b32 v71, 0xffff0000, v223
    v_lshlrev_b32 v28, 16, v212
    v_and_b32 v29, 0xffff0000, v212
    v_lshlrev_b32 v30, 16, v213
    v_and_b32 v31, 0xffff0000, v213
    v_lshlrev_b32 v32, 16, v214
    v_and_b32 v33, 0xffff0000, v214
    v_lshlrev_b32 v34, 16, v215
    v_and_b32 v35, 0xffff0000, v215
    v_sub_f32 v12, v28, v250
    v_sub_f32 v13, v29, v250
    v_sub_f32 v14, v30, v250
    v_sub_f32 v15, v31, v250
    v_sub_f32 v16, v32, v250
    v_sub_f32 v17, v33, v250
    v_sub_f32 v18, v34, v250
    v_sub_f32 v19, v35, v250
    v_mul_f32 v12, v12, v251
    v_add_f32 v28, v28, v64
    v_mul_f32 v13, v13, v251
    v_add_f32 v29, v29, v65
    v_mul_f32 v14, v14, v251
    v_add_f32 v30, v30, v66
    v_mul_f32 v15, v15, v251
    v_add_f32 v31, v31, v67
    v_mul_f32 v16, v16, v251
    v_add_f32 v32, v32, v68
    v_mul_f32 v17, v17, v251
    v_add_f32 v33, v33, v69
    v_mul_f32 v18, v18, v251
    v_add_f32 v34, v34, v70
    v_mul_f32 v19, v19, v251
    v_add_f32 v35, v35, v71
    v_lshlrev_b32 v36, 16, v216
    v_and_b32 v37, 0xffff0000, v216
    v_lshlrev_b32 v38, 16, v217
    v_and_b32 v39, 0xffff0000, v217
    v_lshlrev_b32 v40, 16, v218
    v_and_b32 v41, 0xffff0000, v218
    v_lshlrev_b32 v42, 16, v219
    v_and_b32 v43, 0xffff0000, v219
    v_sub_f32 v20, v36, v252
    v_sub_f32 v21, v37, v252
    v_sub_f32 v22, v38, v252
    v_sub_f32 v23, v39, v252
    v_sub_f32 v24, v40, v252
    v_sub_f32 v25, v41, v252
    v_sub_f32 v26, v42, v252
    v_sub_f32 v27, v43, v252
    v_mul_f32 v20, v20, v253
    v_add_f32 v36, v36, v64
    v_mul_f32 v21, v21, v253
    v_add_f32 v37, v37, v65
    v_mul_f32 v22, v22, v253
    v_add_f32 v38, v38, v66
    v_mul_f32 v23, v23, v253
    v_add_f32 v39, v39, v67
    v_mul_f32 v24, v24, v253
    v_add_f32 v40, v40, v68
    v_mul_f32 v25, v25, v253
    v_add_f32 v41, v41, v69
    v_mul_f32 v26, v26, v253
    v_add_f32 v42, v42, v70
    v_mul_f32 v27, v27, v253
    v_add_f32 v43, v43, v71
    v_lshrrev_b32 v8, 5, v1
    v_and_b32 v9, 3, v1
    v_bfe_u32 v10, v1, 2, 3
    v_lshrrev_b32 v7, 3, v1
    v_and_b32 v152, 7, v1
    v_xor_b32 v152, v152, v8
    v_lshlrev_b32 v152, 4, v152
    v_lshl_or_b32 v152, v7, 7, v152
    v_xor_b32 v153, 32, v152
    v_xor_b32 v154, v8, v9
    v_lshlrev_b32 v154, 4, v154
    v_lshl_or_b32 v154, v9, 9, v154
    v_lshl_or_b32 v154, v10, 1, v154
    v_lshrrev_b32 v7, 2, v1
    v_lshrrev_b32 v159, v7, v4
    v_lshlrev_b32 v158, 16, v159
    v_mov_b32 v44, 0
    v_mov_b32 v45, 0
    v_mov_b32 v46, 0
    v_mov_b32 v47, 0
    v_mov_b32 v48, 0
    v_mov_b32 v49, 0
    v_mov_b32 v50, 0
    v_mov_b32 v51, 0
    v_mov_b32 v52, 0
    v_mov_b32 v53, 0
    v_mov_b32 v54, 0
    v_mov_b32 v55, 0
    v_mov_b32 v56, 0
    v_mov_b32 v57, 0
    v_mov_b32 v58, 0
    v_mov_b32 v59, 0
    s_xor_b32 s61, s3, 1
    s_lshl_b32 s61, s61, 12
    s_add_u32 s61, s61, 114688
    s_mov_b32 m0, s61
    v_xor_b32 v155, 32, v154
    v_add_u32 v154, s61, v154
    v_add_u32 v155, s61, v155
    v_bfe_u32 v156, v1, 3, 1
    v_lshl_or_b32 v156, v156, 3, v10
    v_lshlrev_b32 v9, 1, v9
    v_xor_b32 v156, v156, v9
    s_and_b32 s61, s3, 2
    s_lshl_b32 s61, s61, 2
    v_xor_b32 v156, s61, v156
    v_lshlrev_b32 v156, 4, v156
    v_lshl_or_b32 v156, v10, 8, v156
    v_lshl_or_b32 v156, v8, 14, v156
    s_lshl_b32 s61, s73, 13
    v_add_u32 v156, s61, v156
    v_xor_b32 v157, 16, v156
    s_lshl_b32 s82, s52, 1
    s_add_u32 s82, s82, s6
    s_lshl_b32 s82, s82, 3
    s_add_u32 s82, s82, s7
    s_lshl_b32 s82, s82, 13
    s_add_u32 s82, s82, s81
    s_add_u32 s82, s82, 4194304
    s_cmp_lg_u32 s63, 0
    s_cbranch_scc1 C_E1
    s_mov_b64 exec, 0xff
C_EPOLL:
    s_waitcnt vmcnt(0)
    v_cmp_ne_u32 vcc, v76, v4
    s_cbranch_vccz C_EOK
    buffer_load_dword v76, v77, s[20:23], s62 offen sc1
    s_add_u32 s65, s65, 1
    s_cmp_gt_u32 s65, 200000
    s_cbranch_scc0 C_EPOLL
    s_waitcnt vmcnt(0)
    s_branch C_ENO
C_EOK:
    s_mov_b64 exec, 1
    buffer_store_dword v4, off, s[20:23], 0 sc1
C_ENO:
    s_mov_b64 exec, -1
C_E1:
    s_barrier
    s_mov_b32 s65, 0
C_YLOAD:
    s_setprio 3
    buffer_load_dwordx4 v152, s[20:23], s82 offen offset:0 sc1 lds
    buffer_load_dwordx4 v153, s[20:23], s82 offen offset:1024 sc1 lds
    s_setprio 0
    s_add_u32 s65, s65, 1
    s_waitcnt vmcnt(0)
    ds_read_u16_d16_hi v44, v154 offset:0
    ds_read_u16_d16_hi v45, v154 offset:64
    ds_read_u16_d16_hi v46, v154 offset:128
    ds_read_u16_d16_hi v47, v154 offset:192
    ds_read_u16_d16_hi v48, v154 offset:256
    ds_read_u16_d16_hi v49, v154 offset:320
    ds_read_u16_d16_hi v50, v154 offset:384
    ds_read_u16_d16_hi v51, v154 offset:448
    ds_read_u16_d16_hi v52, v155 offset:0
    ds_read_u16_d16_hi v53, v155 offset:64
    ds_read_u16_d16_hi v54, v155 offset:128
    ds_read_u16_d16_hi v55, v155 offset:192
    ds_read_u16_d16_hi v56, v155 offset:256
    ds_read_u16_d16_hi v57, v155 offset:320
    ds_read_u16_d16_hi v58, v155 offset:384
    ds_read_u16_d16_hi v59, v155 offset:448
    s_waitcnt lgkmcnt(15)
    v_xor_b32 v72, v44, v158
    s_waitcnt lgkmcnt(14)
    v_bitop3_b32 v72, v45, v158, v72 bitop3:0xbe
    s_waitcnt lgkmcnt(13)
    v_bitop3_b32 v72, v46, v158, v72 bitop3:0xbe
    s_waitcnt lgkmcnt(12)
    v_bitop3_b32 v72, v47, v158, v72 bitop3:0xbe
    s_waitcnt lgkmcnt(11)
    v_bitop3_b32 v72, v48, v158, v72 bitop3:0xbe
    s_waitcnt lgkmcnt(10)
    v_bitop3_b32 v72, v49, v158, v72 bitop3:0xbe
    s_waitcnt lgkmcnt(9)
    v_bitop3_b32 v72, v50, v158, v72 bitop3:0xbe
    s_waitcnt lgkmcnt(8)
    v_bitop3_b32 v72, v51, v158, v72 bitop3:0xbe
    s_waitcnt lgkmcnt(7)
    v_bitop3_b32 v72, v52, v159, v72 bitop3:0xbe
    s_waitcnt lgkmcnt(6)
    v_bitop3_b32 v72, v53, v159, v72 bitop3:0xbe
    s_waitcnt lgkmcnt(5)
    v_bitop3_b32 v72, v54, v159, v72 bitop3:0xbe
    s_waitcnt lgkmcnt(4)
    v_bitop3_b32 v72, v55, v159, v72 bitop3:0xbe
    s_waitcnt lgkmcnt(3)
    v_bitop3_b32 v72, v56, v159, v72 bitop3:0xbe
    s_waitcnt lgkmcnt(2)
    v_bitop3_b32 v72, v57, v159, v72 bitop3:0xbe
    s_waitcnt lgkmcnt(1)
    v_bitop3_b32 v72, v58, v159, v72 bitop3:0xbe
    s_waitcnt lgkmcnt(0)
    v_bitop3_b32 v72, v59, v159, v72 bitop3:0xbe
    v_and_b32 v72, 0x10000, v72
    v_cmp_ne_u32 vcc, 0, v72
    s_cmp_gt_u32 s65, 200000
    s_cbranch_scc1 C_YOK
    s_cbranch_vccnz C_YLOAD
C_YOK:
    v_or_b32 v44, 0x10000, v44
    v_or_b32 v45, 0x10000, v45
    v_or_b32 v46, 0x10000, v46
    v_or_b32 v47, 0x10000, v47
    v_or_b32 v48, 0x10000, v48
    v_or_b32 v49, 0x10000, v49
    v_or_b32 v50, 0x10000, v50
    v_or_b32 v51, 0x10000, v51
    v_or_b32 v52, 0x10000, v52
    v_or_b32 v53, 0x10000, v53
    v_or_b32 v54, 0x10000, v54
    v_or_b32 v55, 0x10000, v55
    v_or_b32 v56, 0x10000, v56
    v_or_b32 v57, 0x10000, v57
    v_or_b32 v58, 0x10000, v58
    v_or_b32 v59, 0x10000, v59
    v_fmac_f32 v28, v12, v44
    v_fmac_f32 v29, v13, v45
    v_fmac_f32 v30, v14, v46
    v_fmac_f32 v31, v15, v47
    v_fmac_f32 v32, v16, v48
    v_fmac_f32 v33, v17, v49
    v_fmac_f32 v34, v18, v50
    v_fmac_f32 v35, v19, v51
    v_fmac_f32 v36, v20, v52
    v_fmac_f32 v37, v21, v53
    v_fmac_f32 v38, v22, v54
    v_fmac_f32 v39, v23, v55
    v_fmac_f32 v40, v24, v56
    v_fmac_f32 v41, v25, v57
    v_fmac_f32 v42, v26, v58
    v_fmac_f32 v43, v27, v59
    s_barrier
    ds_read_b128 v[76:79], v156 offset:0
    ds_read_b128 v[80:83], v157 offset:0
    ds_read_b128 v[84:87], v156 offset:2048
    ds_read_b128 v[88:91], v157 offset:2048
    ds_read_b128 v[92:95], v156 offset:4096
    ds_read_b128 v[96:99], v157 offset:4096
    ds_read_b128 v[100:103], v156 offset:6144
    ds_read_b128 v[104:107], v157 offset:6144
    s_waitcnt lgkmcnt(7)
    v_add_f32 v28, v28, v76
    v_add_f32 v29, v29, v77
    v_add_f32 v30, v30, v78
    v_add_f32 v31, v31, v79
    s_waitcnt lgkmcnt(6)
    v_add_f32 v32, v32, v80
    v_add_f32 v33, v33, v81
    v_add_f32 v34, v34, v82
    v_add_f32 v35, v35, v83
    s_waitcnt lgkmcnt(5)
    v_add_f32 v28, v28, v84
    v_add_f32 v29, v29, v85
    v_add_f32 v30, v30, v86
    v_add_f32 v31, v31, v87
    s_waitcnt lgkmcnt(4)
    v_add_f32 v32, v32, v88
    v_add_f32 v33, v33, v89
    v_add_f32 v34, v34, v90
    v_add_f32 v35, v35, v91
    s_waitcnt lgkmcnt(3)
    v_add_f32 v28, v28, v92
    v_add_f32 v29, v29, v93
    v_add_f32 v30, v30, v94
    v_add_f32 v31, v31, v95
    s_waitcnt lgkmcnt(2)
    v_add_f32 v32, v32, v96
    v_add_f32 v33, v33, v97
    v_add_f32 v34, v34, v98
    v_add_f32 v35, v35, v99
    s_waitcnt lgkmcnt(1)
    v_add_f32 v28, v28, v100
    v_add_f32 v29, v29, v101
    v_add_f32 v30, v30, v102
    v_add_f32 v31, v31, v103
    s_waitcnt lgkmcnt(0)
    v_add_f32 v32, v32, v104
    v_add_f32 v33, v33, v105
    v_add_f32 v34, v34, v106
    v_add_f32 v35, v35, v107
    v_cvt_pk_bf16_f32 v212, v28, v29
    v_cvt_pk_bf16_f32 v213, v30, v31
    v_cvt_pk_bf16_f32 v214, v32, v33
    v_cvt_pk_bf16_f32 v215, v34, v35
    buffer_store_dwordx4 v[212:215], v211, s[40:43], s74 offen sc1
    s_barrier
    ds_read_b128 v[108:111], v156 offset:32768
    ds_read_b128 v[112:115], v157 offset:32768
    ds_read_b128 v[116:119], v156 offset:34816
    ds_read_b128 v[120:123], v157 offset:34816
    ds_read_b128 v[124:127], v156 offset:36864
    ds_read_b128 v[128:131], v157 offset:36864
    ds_read_b128 v[132:135], v156 offset:38912
    ds_read_b128 v[136:139], v157 offset:38912
    s_waitcnt lgkmcnt(7)
    v_pk_add_f32 v[36:37], v[36:37], v[108:109]
    v_pk_add_f32 v[38:39], v[38:39], v[110:111]
    s_waitcnt lgkmcnt(6)
    v_pk_add_f32 v[40:41], v[40:41], v[112:113]
    v_pk_add_f32 v[42:43], v[42:43], v[114:115]
    s_waitcnt lgkmcnt(5)
    v_pk_add_f32 v[36:37], v[36:37], v[116:117]
    v_pk_add_f32 v[38:39], v[38:39], v[118:119]
    s_waitcnt lgkmcnt(4)
    v_pk_add_f32 v[40:41], v[40:41], v[120:121]
    v_pk_add_f32 v[42:43], v[42:43], v[122:123]
    s_waitcnt lgkmcnt(3)
    v_pk_add_f32 v[36:37], v[36:37], v[124:125]
    v_pk_add_f32 v[38:39], v[38:39], v[126:127]
    s_waitcnt lgkmcnt(2)
    v_pk_add_f32 v[40:41], v[40:41], v[128:129]
    v_pk_add_f32 v[42:43], v[42:43], v[130:131]
    s_waitcnt lgkmcnt(1)
    v_pk_add_f32 v[36:37], v[36:37], v[132:133]
    v_pk_add_f32 v[38:39], v[38:39], v[134:135]
    s_waitcnt lgkmcnt(0)
    v_pk_add_f32 v[40:41], v[40:41], v[136:137]
    v_pk_add_f32 v[42:43], v[42:43], v[138:139]
    v_cvt_pk_bf16_f32 v216, v36, v37
    v_cvt_pk_bf16_f32 v217, v38, v39
    v_cvt_pk_bf16_f32 v218, v40, v41
    v_cvt_pk_bf16_f32 v219, v42, v43
    buffer_store_dwordx4 v[216:219], v211, s[40:43], s75 offen
L_END:
    s_endpgm
.section .rodata,"a"
.p2align 6
.amdhsa_kernel parallel_sum__ssm_conv_h3__mixer_channel_mlp__prompt_kernel
  .amdhsa_next_free_vgpr 256
  .amdhsa_next_free_sgpr 102
  .amdhsa_accum_offset 256
  .amdhsa_group_segment_fixed_size 0
  .amdhsa_kernarg_size 112
  .amdhsa_user_sgpr_count 2
  .amdhsa_user_sgpr_kernarg_segment_ptr 1
  .amdhsa_system_sgpr_workgroup_id_x 1
  .amdhsa_float_denorm_mode_32 3
.end_amdhsa_kernel
```
